```python
import torch

def _softmax(x, axis=-1):
    return torch.softmax(x, dim=axis)
def _gelu(x):
    return torch.nn.functional.gelu(x, approximate="tanh")
def _silu(x):
    return torch.nn.functional.silu(x)
def _sigmoid(x):
    return torch.sigmoid(x)
def _layernorm(x, axis=-1, eps=1e-5):
    m = x.mean(dim=axis, keepdim=True)
    v = x.var(dim=axis, keepdim=True, unbiased=False)
    return (x - m) / torch.sqrt(v + eps)
def _scatter_add(tgt, idx, src, axis=0):
    return tgt.clone().index_add_(axis, idx, src)
def _segment_sum(src, seg, n):
    out = torch.zeros((n,) + src.shape[1:], dtype=src.dtype)
    return out.index_add_(0, seg, src)
def _pad(x, pw):
    flat = tuple(v for pair in reversed(pw) for v in pair)
    return torch.nn.functional.pad(x, flat)

kernel_name = 'sequential_preLN__mha_block_cached__geglu_ffn__decode'

def setup_inputs():

    _w = (lambda a: (lambda t: t.to(torch.bfloat16) if t.is_floating_point() else t)(torch.as_tensor(a)))
    def _A_setup():
        B, Sq, D = 8, 1, 640
        H, Sk, Dh = 32, 4096, 128
        return {
            "x": _w((lambda *s: torch.randn(*s, dtype=torch.bfloat16) * 0.05)(B, Sq, D)),
            "k_cache": _w((lambda *s: torch.randn(*s, dtype=torch.bfloat16) * 3.2)(B, H, Sk, Dh)),
            "v_cache": _w((lambda *s: torch.randn(*s, dtype=torch.bfloat16) * 0.4)(B, H, Sk, Dh)),
            "wq": _w((lambda *s: torch.randn(*s, dtype=torch.bfloat16) * 3.2)(D, H * Dh) * (D ** -0.5)),
            "wo": _w((lambda *s: torch.randn(*s, dtype=torch.bfloat16) * 0.4)(H * Dh, D) * ((H * Dh) ** -0.5)),
        }
    _A_in = _A_setup()

    def _B_setup():
        B, S, D, F = 8, 1, 640, 1728
        return {
            "x": _w((lambda *s: torch.randn(*s, dtype=torch.bfloat16) * 0.05)(B, S, D)),
            "w_gate": _w((lambda *s: torch.randn(*s, dtype=torch.bfloat16) * 0.05)(D, F)),
            "w_up": _w((lambda *s: torch.randn(*s, dtype=torch.bfloat16) * 0.05)(D, F)),
            "w_down": _w((lambda *s: torch.randn(*s, dtype=torch.bfloat16) * 0.05)(F, D)),
        }
    _B_in = _B_setup()

    return {
        "A_x": _A_in["x"],
        "A_k_cache": _A_in["k_cache"],
        "A_v_cache": _A_in["v_cache"],
        "A_wq": _A_in["wq"],
        "A_wo": _A_in["wo"],
        "B_x": _B_in["x"],
        "B_w_gate": _B_in["w_gate"],
        "B_w_up": _B_in["w_up"],
        "B_w_down": _B_in["w_down"],
    }

def reference(A_x, A_k_cache, A_v_cache, A_wq, A_wo, B_x, B_w_gate, B_w_up, B_w_down):
    def _A_ref(x, k_cache, v_cache, wq, wo):
        B, Sq, D = x.shape
        H, Dh = 32, 128
        q = (lambda x, *d: x.permute(*d))((x @ wq).reshape(B, Sq, H, Dh), 0, 2, 1, 3)
        scores = torch.einsum("bhqd,bhkd->bhqk", q, k_cache) * (Dh ** -0.5)
        p = _softmax(scores, axis=-1)
        o = torch.einsum("bhqk,bhkd->bhqd", p, v_cache)
        return (lambda x, *d: x.permute(*d))(o, 0, 2, 1, 3).reshape(B, Sq, H * Dh) @ wo

    def _B_ref(x, w_gate, w_up, w_down):
        return (_gelu(x @ w_gate) * (x @ w_up)) @ w_down

    x = A_x
    h = x + _A_ref(_layernorm(x, axis=-1), A_k_cache, A_v_cache, A_wq, A_wo)
    h2 = h + _B_ref(_layernorm(h, axis=-1), B_w_gate, B_w_up, B_w_down)
    return h2
```

```asm
; @launch grid=(256,1,1) block=(512,1,1) lds=114688
.amdgcn_target "amdgcn-amd-amdhsa--gfx950"
.text
.globl sequential_preLN__mha_block_cached__geglu_ffn__decode_kernel
.p2align 8
.type sequential_preLN__mha_block_cached__geglu_ffn__decode_kernel,@function
sequential_preLN__mha_block_cached__geglu_ffn__decode_kernel:
  s_cmp_ge_u32 s2, 256
  s_cbranch_scc1 L_end
  s_mov_b32 s101, 0
L_start:
  s_load_dwordx16 s[64:79], s[0:1], 0
  s_load_dwordx8 s[80:87], s[0:1], 64
  v_lshrrev_b32 v8, 6, v0
  v_and_b32 v1, 63, v0
  v_readfirstlane_b32 s3, v8
  v_and_b32 v3, 15, v0
  s_memrealtime s[94:95]
  s_lshr_b32 s38, s2, 5
  s_and_b32 s39, s2, 31
  v_lshlrev_b32 v250, 4, v1
  s_mul_i32 s42, s3, 1024
  v_add_u32 v2, s42, v250
  v_bfe_u32 v9, v0, 4, 2
  s_and_b32 s42, s3, 2
  s_lshl_b32 s42, s42, 2
  v_lshl_or_b32 v16, v9, 1, s42
  v_xor_b32 v16, v16, v3
  v_lshlrev_b32 v16, 4, v16
  s_lshl_b32 s42, s3, 2
  v_add_u32 v10, s42, v9
  v_lshl_add_u32 v120, v10, 13, v16
  v_lshlrev_b32 v15, 2, v1
  v_lshlrev_b32 v247, 3, v1
  s_mul_i32 s47, s3, 1280
  s_lshl_b32 s48, s39, 8
  s_mul_i32 s49, s38, 655360
  s_add_u32 s49, s49, s48
  s_mul_i32 s61, s38, 160
  s_lshl_b32 s46, s2, 20
  s_lshl_b32 s91, s3, 10
  s_add_u32 s91, s91, 32768
  s_lshl_b32 s92, s39, 16
  s_add_u32 s92, s92, 4194304
  s_lshl_b32 s42, s38, 13
  s_add_u32 s93, s92, s42
  s_lshl_b32 s42, s38, 3
  s_add_u32 s42, s42, s3
  s_lshl_b32 s42, s42, 7
  s_add_u32 s92, s92, s42
  v_mov_b32 v121, 0
  s_waitcnt lgkmcnt(0)
  s_add_u32 s28, s64, s47
  s_addc_u32 s29, s65, 0
  s_mov_b32 s30, 1280
  s_mov_b32 s31, 0x00020000
  buffer_load_dwordx4 v[240:243], v250, s[28:31], 0 offen
  buffer_load_dword v244, v15, s[28:31], 0 offen offset:1024
  buffer_load_dword v245, v15, s[28:31], s61 offen
  s_add_u32 s16, s70, s49
  s_addc_u32 s17, s71, 0
  s_mov_b32 s18, 647424
  s_mov_b32 s19, 0x00020000
  s_add_u32 m0, s91, 0
  s_nop 0
  buffer_load_dwordx4 v120, s[16:19], 0 offen nt lds
  s_add_u32 m0, s91, 8192
  s_mov_b32 s42, 262144
  buffer_load_dwordx4 v120, s[16:19], s42 offen nt lds
  s_add_u32 m0, s91, 16384
  s_mov_b32 s42, 524288
  buffer_load_dwordx4 v120, s[16:19], s42 offen nt lds
  s_add_u32 s24, s86, 0
  s_addc_u32 s25, s87, 0
  s_mov_b32 s26, 6291456
  s_mov_b32 s27, 0x00020000
  s_mov_b64 exec, 1
  buffer_load_dword v128, v250, s[24:27], s93 offen sc1
  s_mov_b64 exec, -1
  s_add_u32 s4, s66, s46
  s_addc_u32 s5, s67, 0
  s_mov_b32 s6, 1048576
  s_mov_b32 s7, 0x00020000
  buffer_load_dwordx4 v[160:163], v2, s[4:7], 0 offen offset:0 nt
  s_mov_b32 s44, 0
  s_mov_b32 s45, 0
  s_mov_b32 s46, 0
  s_mov_b32 s57, 0
  s_mov_b32 s60, 0
  s_mov_b32 s58, s72
  s_mov_b32 s59, s73
  s_mov_b32 s56, 2147483632
  s_mov_b32 s13, 0
  s_mov_b32 s14, 2
  s_mov_b32 s49, 0
  s_mov_b32 s37, 0
  v_mov_b32 v249, 2147483632
  s_lshl_b32 s43, s39, 3
  s_add_u32 s43, s43, s38
  s_and_b32 s12, s38, 1
  v_bfe_u32 v17, v0, 3, 1
  s_cmp_lt_u32 s39, 10
  s_cbranch_scc0 L_r1
  s_mov_b32 s44, 1
  s_movk_i32 s46, 1280
  s_movk_i32 s60, 128
  s_mov_b32 s49, 8
  s_mov_b32 s37, 21845
  s_mul_i32 s61, s43, 205
  s_lshr_b32 s61, s61, 12
  s_mul_i32 s42, s61, 20
  s_sub_u32 s45, s43, s42
  s_lshl_b32 s13, s45, 6
  s_lshl_b32 s57, s61, 10
  s_lshl_b32 s42, s3, 7
  s_add_u32 s57, s57, s42
  s_mul_i32 s56, s61, 20480
  s_lshl_b32 s42, s45, 7
  s_add_u32 s56, s56, s42
  s_add_u32 s56, s56, 65536
  s_movk_i32 s42, 2560
  v_and_b32 v16, 7, v0
  v_mul_lo_u32 v18, v16, s42
  v_lshl_add_u32 v18, v9, 4, v18
  v_lshl_add_u32 v18, v17, 6, v18
  s_mov_b64 vcc, -1
  s_branch L_r3
L_r1:
  s_cmp_lt_u32 s39, 24
  s_cbranch_scc0 L_r2
  s_sub_u32 s45, s43, 80
  s_lshr_b32 s45, s45, 1
  s_cmp_lt_u32 s45, 54
  s_cbranch_scc0 L_r4
  s_movk_i32 s46, 3456
  s_bitcmp1_b32 s3, 0
  s_cselect_b32 s58, s78, s76
  s_cselect_b32 s59, s79, s77
  s_lshr_b32 s42, s3, 1
  s_mul_i32 s57, s42, 160
  s_mov_b32 s44, 2
  s_movk_i32 s60, 160
  s_mov_b32 s49, 10
  s_mov_b32 s37, 9362
  s_lshl_b32 s13, s45, 6
  s_lshl_b32 s56, s45, 9
  s_lshl_b32 s42, s12, 8
  s_add_u32 s56, s56, s42
  s_add_u32 s56, s56, 163840
  v_lshrrev_b32 v18, 1, v9
  v_lshl_add_u32 v18, v17, 1, v18
  v_lshlrev_b32 v18, 6, v18
  v_and_b32 v16, 3, v0
  v_lshl_add_u32 v18, v16, 4, v18
  v_and_b32 v20, 0x14, v0
  v_cmp_eq_u32 vcc, 0, v20
  s_branch L_r3
L_r2:
  s_cmp_lt_u32 s39, 29
  s_cbranch_scc0 L_r4
  s_mov_b32 s44, 3
  s_movk_i32 s46, 1280
  s_mov_b32 s49, 7
  s_mov_b32 s37, 4680
  s_mov_b32 s14, 1
  s_sub_u32 s45, s43, 192
  s_lshl_b32 s13, s45, 5
  s_mov_b32 s58, s80
  s_mov_b32 s59, s81
  s_mul_i32 s57, s3, 224
  s_sub_u32 s60, 1728, s57
  s_min_u32 s60, s60, 224
  s_branch L_r4
L_r3:
  v_add_u32 v18, s56, v18
  v_cndmask_b32 v249, v249, v18, vcc
L_r4:
  s_mul_i32 s42, s57, s46
  s_add_u32 s42, s42, s13
  s_mul_i32 s60, s60, s46
  s_sub_u32 s62, s60, s13
  s_cmp_eq_u32 s60, 0
  s_cselect_b32 s60, 0, s62
  s_add_u32 s20, s58, s42
  s_addc_u32 s21, s59, 0
  s_mov_b32 s22, s60
  s_mov_b32 s23, 0x00020000
  v_lshrrev_b32 v18, s14, v1
  v_mul_lo_u32 v18, v18, s46
  s_bfm_b32 s42, s14, 0
  v_and_b32 v19, s42, v0
  s_and_b32 s42, s3, 1
  s_lshl_b32 s42, s42, 1
  v_bfe_u32 v20, v0, 5, 1
  v_or_b32 v20, s42, v20
  s_cmp_eq_u32 s44, 2
  s_cselect_b32 s42, 3, 0
  v_and_b32 v20, s42, v20
  v_xor_b32 v19, v19, v20
  v_lshl_add_u32 v39, v19, 4, v18
  s_sub_u32 s42, 6, s14
  s_lshl_b32 s46, s46, s42
  s_mul_i32 s91, s3, 10240
  s_add_u32 s91, s91, 32768
  s_mov_b32 s90, 0
  s_mov_b32 s98, 0
  s_lshl_b32 s36, s3, 11
  s_add_u32 s36, s36, 16384
  s_lshl_b32 s42, s2, 20
  s_add_u32 s8, s68, s42
  s_addc_u32 s9, s69, 0
  s_mov_b32 s10, 1048576
  s_mov_b32 s11, 0x00020000
  s_add_u32 s32, s82, 0
  s_addc_u32 s33, s83, 0
  s_mov_b32 s34, 10240
  s_mov_b32 s35, 0x00020000
  s_lshl_b32 s42, s38, 13
  s_add_u32 s42, s42, s48
  v_add_u32 v16, s42, v15
  v_mov_b32 v17, 2147483632
  v_mov_b32 v248, v16
  v_mov_b32 v24, -1
  v_mov_b32 v25, -1
  v_mov_b32 v26, -1
  v_mov_b32 v27, -1
  v_cmp_eq_u32 vcc, 0, v1
  s_lshr_b32 s43, s39, 3
  s_mul_i32 s42, s43, 1
  s_lshr_b32 s47, s38, 3
  s_add_u32 s42, s42, s47
  s_sub_u32 s42, s42, s39
  s_and_b32 s42, s42, 3
  s_lshl_b32 s42, s42, 3
  s_and_b32 s47, s39, 7
  s_add_u32 s42, s42, s47
  s_mul_i32 s42, s42, 256
  s_add_u32 s42, s42, 1048576
  s_add_u32 s43, s43, s38
  s_and_b32 s43, s43, 7
  s_cselect_b32 s42, 2147483632, s42
  v_mov_b32 v16, s42
  v_cndmask_b32 v36, v17, v16, vcc
  v_cmp_gt_u32 vcc, 8, v1
  s_mov_b32 s42, 256
  v_mul_lo_u32 v16, v1, s42
  v_cndmask_b32 v35, v17, v16, vcc
  v_mov_b32 v33, 0
  s_mov_b32 s96, 3
  s_mov_b32 s61, s96
  v_bfrev_b32 v16, 1
  ds_write_b32 v33, v16 offset:6208
  s_lshl_b32 s42, s3, 9
  v_lshlrev_b32 v16, 5, v3
  v_lshl_add_u32 v16, v9, 3, v16
  v_add_u32 v246, s42, v16
  s_mov_b32 s50, 0xcccccccc
  s_mov_b32 s51, 0xcccccccc
  s_mov_b32 s52, 0xaaaaaaaa
  s_mov_b32 s53, 0xaaaaaaaa
  s_mov_b32 s54, 1035273459
  s_mov_b32 s55, 1069066811
  v_mov_b32 v72, 0
  v_mov_b32 v73, 0
  v_mov_b32 v74, 0
  v_mov_b32 v75, 0
  v_mov_b32 v76, 0
  v_mov_b32 v77, 0
  v_mov_b32 v78, 0
  v_mov_b32 v79, 0
  v_bfe_u32 v16, v0, 2, 2
  v_and_b32 v17, 1, v9
  v_lshl_or_b32 v17, v17, 2, v16
  v_xor_b32 v17, s3, v17
  v_lshl_add_u32 v16, v9, 3, v16
  v_lshlrev_b32 v16, 8, v16
  v_lshl_add_u32 v16, v17, 5, v16
  v_and_b32 v17, 3, v0
  v_lshl_add_u32 v116, v17, 3, v16
  v_and_b32 v16, 7, v0
  v_mul_u32_u24 v17, 320, v16
  v_lshl_add_u32 v117, v9, 4, v17
  v_bfe_u32 v17, v0, 3, 1
  v_lshl_add_u32 v17, v9, 1, v17
  v_lshlrev_b32 v17, 4, v17
  v_lshl_add_u32 v118, v16, 13, v17
  s_mul_i32 s42, s3, 320
  v_add_u32 v119, s42, v15
  s_cmp_lg_u32 s3, 7
  s_cbranch_scc1 L_non1
  v_mov_b32 v122, s94
  v_mov_b32 v123, s95
  ds_write_b64 v121, v[122:123] offset:6224
L_non1:
  ds_write_b32 v33, v33 offset:6240
  ds_write_b32 v33, v33 offset:6248
  ds_write_b32 v33, v33 offset:6252
  s_cmp_lg_u32 s101, 0
  s_cselect_b32 s92, 2147483632, s92
  s_cbranch_scc1 L_vf0
  ds_write_b32 v33, v33 offset:6244
L_vf0:
  s_mov_b32 s62, 0xff00ff00
  s_mov_b32 s63, 0xff00ff00
  s_waitcnt vmcnt(5)
  s_mov_b32 s42, 8192
  buffer_load_dwordx4 v[164:167], v2, s[4:7], s42 offen offset:0 nt
  s_mov_b32 s42, 16384
  buffer_load_dwordx4 v[168:171], v2, s[4:7], s42 offen offset:0 nt
  s_mov_b32 s42, 24576
  buffer_load_dwordx4 v[172:175], v2, s[4:7], s42 offen offset:0 nt
  v_lshlrev_b32 v224, 16, v240
  v_and_b32 v225, 0xffff0000, v240
  v_lshlrev_b32 v226, 16, v241
  v_and_b32 v227, 0xffff0000, v241
  v_lshlrev_b32 v228, 16, v242
  v_and_b32 v229, 0xffff0000, v242
  v_lshlrev_b32 v230, 16, v243
  v_and_b32 v231, 0xffff0000, v243
  v_lshlrev_b32 v232, 16, v244
  v_and_b32 v233, 0xffff0000, v244
  v_readfirstlane_b32 s42, v224
  s_nop 1
  v_subrev_f32 v234, s42, v224
  v_mul_f32 v235, v234, v234
  v_subrev_f32 v236, s42, v225
  v_add_f32 v234, v234, v236
  v_fmac_f32 v235, v236, v236
  v_subrev_f32 v236, s42, v226
  v_add_f32 v234, v234, v236
  v_fmac_f32 v235, v236, v236
  v_subrev_f32 v236, s42, v227
  v_add_f32 v234, v234, v236
  v_fmac_f32 v235, v236, v236
  v_subrev_f32 v236, s42, v228
  v_add_f32 v234, v234, v236
  v_fmac_f32 v235, v236, v236
  v_subrev_f32 v236, s42, v229
  v_add_f32 v234, v234, v236
  v_fmac_f32 v235, v236, v236
  v_subrev_f32 v236, s42, v230
  v_add_f32 v234, v234, v236
  v_fmac_f32 v235, v236, v236
  v_subrev_f32 v236, s42, v231
  v_add_f32 v234, v234, v236
  v_fmac_f32 v235, v236, v236
  v_subrev_f32 v236, s42, v232
  v_add_f32 v234, v234, v236
  v_fmac_f32 v235, v236, v236
  v_subrev_f32 v236, s42, v233
  v_add_f32 v234, v234, v236
  v_fmac_f32 v235, v236, v236
  s_nop 0
  v_add_f32_dpp v234, v234, v234 row_ror:8 row_mask:0xf bank_mask:0xf
  v_add_f32_dpp v235, v235, v235 row_ror:8 row_mask:0xf bank_mask:0xf
  s_nop 0
  v_add_f32_dpp v234, v234, v234 row_ror:4 row_mask:0xf bank_mask:0xf
  v_add_f32_dpp v235, v235, v235 row_ror:4 row_mask:0xf bank_mask:0xf
  s_nop 0
  v_add_f32_dpp v234, v234, v234 row_ror:2 row_mask:0xf bank_mask:0xf
  v_add_f32_dpp v235, v235, v235 row_ror:2 row_mask:0xf bank_mask:0xf
  s_nop 0
  v_add_f32_dpp v234, v234, v234 row_ror:1 row_mask:0xf bank_mask:0xf
  v_add_f32_dpp v235, v235, v235 row_ror:1 row_mask:0xf bank_mask:0xf
  v_mov_b32 v252, v234
  v_mov_b32 v253, v235
  s_nop 0
  v_permlane16_swap_b32 v234, v252
  v_permlane16_swap_b32 v235, v253
  v_add_f32 v234, v234, v252
  v_add_f32 v235, v235, v253
  v_mov_b32 v252, v234
  v_mov_b32 v253, v235
  s_nop 0
  v_permlane32_swap_b32 v234, v252
  v_permlane32_swap_b32 v235, v253
  v_add_f32 v234, v234, v252
  v_add_f32 v235, v235, v253
  s_mov_b32 s43, 0x3acccccd
  v_mul_f32 v234, s43, v234
  v_mul_f32 v235, s43, v235
  v_fma_f32 v235, -v234, v234, v235
  v_max_f32 v235, 0, v235
  v_add_f32 v234, s42, v234
  v_cvt_pk_bf16_f32 v237, 0, v234
  v_cvt_pk_bf16_f32 v235, 0, v235
  v_add_f32 v235, 0x3727c5ac, v235
  v_cvt_pk_bf16_f32 v235, 0, v235
  v_sqrt_f32 v235, v235
  s_nop 0
  v_cvt_pk_bf16_f32 v235, 0, v235
  v_rcp_f32 v238, v235
  v_lshlrev_b32 v224, 16, v245
  v_and_b32 v225, 0xffff0000, v245
  v_sub_f32 v224, v224, v237
  v_sub_f32 v225, v225, v237
  v_cvt_pk_bf16_f32 v226, v224, v225
  v_lshlrev_b32 v224, 16, v226
  v_and_b32 v225, 0xffff0000, v226
  v_mul_f32 v224, v224, v238
  v_mul_f32 v225, v225, v238
  v_cvt_pk_bf16_f32 v226, v224, v225
  ds_write_b32 v119, v226 offset:8192
  s_waitcnt vmcnt(5)
  s_waitcnt lgkmcnt(0)
  s_barrier
  s_mov_b32 s42, 32768
  buffer_load_dwordx4 v[176:179], v2, s[4:7], s42 offen offset:0 nt
  ds_read_b128 v[92:95], v117 offset:8192
  ds_read_b64_tr_b16 v[80:81], v116 offset:32768
  ds_read_b64_tr_b16 v[82:83], v116 offset:33792
  ds_read_b128 v[96:99], v117 offset:8256
  ds_read_b64_tr_b16 v[84:85], v116 offset:40960
  ds_read_b64_tr_b16 v[86:87], v116 offset:41984
  ds_read_b128 v[100:103], v117 offset:8320
  ds_read_b64_tr_b16 v[88:89], v116 offset:49152
  ds_read_b64_tr_b16 v[90:91], v116 offset:50176
  ds_read_b64 v[122:123], v121 offset:6224
  s_waitcnt lgkmcnt(7)
  v_mfma_f32_16x16x32_bf16 v[104:107], v[80:83], v[92:95], 0
  s_waitcnt lgkmcnt(4)
  v_mfma_f32_16x16x32_bf16 v[104:107], v[84:87], v[96:99], v[104:107]
  s_waitcnt lgkmcnt(1)
  v_mfma_f32_16x16x32_bf16 v[104:107], v[88:91], v[100:103], v[104:107]
  s_nop 7
  v_cndmask_b32 v108, v104, v106, s[62:63]
  v_cndmask_b32 v109, v105, v107, s[62:63]
  s_waitcnt lgkmcnt(0)
  v_xor_b32 v110, v108, v122
  v_xor_b32 v111, v109, v123
  v_mov_b32 v28, v122
  v_mov_b32 v29, v123
  buffer_store_dwordx4 v[108:111], v118, s[24:27], s92 offen sc1
  v_lshlrev_b32 v242, 4, v3
  s_cmp_lg_u32 s3, 0
  s_cbranch_scc1 L_pump
  s_add_u32 s47, s93, 4096
  v_readfirstlane_b32 s97, v122
  v_readfirstlane_b32 s99, v123
  s_mov_b32 s41, 0
  s_mov_b32 s40, 0xffff0000
  s_waitcnt vmcnt(3)
  s_mov_b32 s42, 40960
  buffer_load_dwordx4 v[180:183], v2, s[4:7], s42 offen offset:0 nt
  s_waitcnt vmcnt(3)
  s_mov_b32 s42, 49152
  buffer_load_dwordx4 v[184:187], v2, s[4:7], s42 offen offset:0 nt
  s_waitcnt vmcnt(3)
  s_mov_b32 s42, 57344
  buffer_load_dwordx4 v[188:191], v2, s[4:7], s42 offen offset:0 nt
  s_waitcnt vmcnt(3)
  s_mov_b32 s42, 65536
  buffer_load_dwordx4 v[192:195], v2, s[4:7], s42 offen offset:0 nt
  buffer_load_dwordx4 v[128:131], v250, s[24:27], s93 offen offset:0 sc1
  buffer_load_dwordx4 v[132:135], v250, s[24:27], s93 offen offset:1024 sc1
  buffer_load_dwordx4 v[136:139], v250, s[24:27], s93 offen offset:2048 sc1
  buffer_load_dwordx4 v[140:143], v250, s[24:27], s93 offen offset:3072 sc1
  buffer_load_dwordx4 v[144:147], v250, s[24:27], s47 offen offset:0 sc1
  buffer_load_dwordx4 v[148:151], v250, s[24:27], s47 offen offset:1024 sc1
  buffer_load_dwordx4 v[152:155], v250, s[24:27], s47 offen offset:2048 sc1
  buffer_load_dwordx4 v[156:159], v250, s[24:27], s47 offen offset:3072 sc1
  s_mov_b32 s42, 73728
  buffer_load_dwordx4 v[196:199], v2, s[4:7], s42 offen offset:0 nt
  s_mov_b32 s42, 81920
  buffer_load_dwordx4 v[200:203], v2, s[4:7], s42 offen offset:0 nt
  s_mov_b32 s42, 90112
  buffer_load_dwordx4 v[204:207], v2, s[4:7], s42 offen offset:0 nt
  s_mov_b32 s42, 98304
  buffer_load_dwordx4 v[208:211], v2, s[4:7], s42 offen offset:0 nt
  s_cmp_lg_u32 s101, 0
  s_cbranch_scc1 L_qto
  s_sub_u32 s97, s97, 1000
  s_waitcnt vmcnt(4)
  s_branch L_qc
L_qr:
  v_cmp_ne_u32 vcc, 0, v88
  s_cbranch_vccz L_qs0
  buffer_load_dwordx4 v[128:131], v250, s[24:27], s93 offen offset:0 sc1
L_qs0:
  v_cmp_ne_u32 vcc, 0, v89
  s_cbranch_vccz L_qs1
  buffer_load_dwordx4 v[132:135], v250, s[24:27], s93 offen offset:1024 sc1
L_qs1:
  v_cmp_ne_u32 vcc, 0, v90
  s_cbranch_vccz L_qs2
  buffer_load_dwordx4 v[136:139], v250, s[24:27], s93 offen offset:2048 sc1
L_qs2:
  v_cmp_ne_u32 vcc, 0, v91
  s_cbranch_vccz L_qs3
  buffer_load_dwordx4 v[140:143], v250, s[24:27], s93 offen offset:3072 sc1
L_qs3:
  v_cmp_ne_u32 vcc, 0, v92
  s_cbranch_vccz L_qs4
  buffer_load_dwordx4 v[144:147], v250, s[24:27], s47 offen offset:0 sc1
L_qs4:
  v_cmp_ne_u32 vcc, 0, v93
  s_cbranch_vccz L_qs5
  buffer_load_dwordx4 v[148:151], v250, s[24:27], s47 offen offset:1024 sc1
L_qs5:
  v_cmp_ne_u32 vcc, 0, v94
  s_cbranch_vccz L_qs6
  buffer_load_dwordx4 v[152:155], v250, s[24:27], s47 offen offset:2048 sc1
L_qs6:
  v_cmp_ne_u32 vcc, 0, v95
  s_cbranch_vccz L_qs7
  buffer_load_dwordx4 v[156:159], v250, s[24:27], s47 offen offset:3072 sc1
L_qs7:
  s_add_u32 s41, s41, 1
  s_cmp_gt_u32 s41, 60
  s_cbranch_scc1 L_qto
  s_waitcnt vmcnt(0)
L_qc:
  v_xor_b32 v80, v130, v128
  v_xor_b32 v81, v134, v132
  v_xor_b32 v82, v138, v136
  v_xor_b32 v83, v142, v140
  v_xor_b32 v84, v146, v144
  v_xor_b32 v85, v150, v148
  v_xor_b32 v86, v154, v152
  v_xor_b32 v87, v158, v156
  v_bitop3_b32 v88, v131, v129, s99 bitop3:0x96
  v_bitop3_b32 v89, v135, v133, s99 bitop3:0x96
  v_bitop3_b32 v90, v139, v137, s99 bitop3:0x96
  v_bitop3_b32 v91, v143, v141, s99 bitop3:0x96
  v_bitop3_b32 v92, v147, v145, s99 bitop3:0x96
  v_bitop3_b32 v93, v151, v149, s99 bitop3:0x96
  v_bitop3_b32 v94, v155, v153, s99 bitop3:0x96
  v_bitop3_b32 v95, v159, v157, s99 bitop3:0x96
  v_subrev_u32 v224, s97, v80
  v_subrev_u32 v225, s97, v81
  v_subrev_u32 v226, s97, v82
  v_subrev_u32 v227, s97, v83
  v_subrev_u32 v228, s97, v84
  v_subrev_u32 v229, s97, v85
  v_subrev_u32 v230, s97, v86
  v_subrev_u32 v231, s97, v87
  v_and_or_b32 v88, v224, s40, v88
  v_and_or_b32 v89, v225, s40, v89
  v_and_or_b32 v90, v226, s40, v90
  v_and_or_b32 v91, v227, s40, v91
  v_and_or_b32 v92, v228, s40, v92
  v_and_or_b32 v93, v229, s40, v93
  v_and_or_b32 v94, v230, s40, v94
  v_and_or_b32 v95, v231, s40, v95
  v_or3_b32 v224, v88, v89, v90
  v_or3_b32 v225, v91, v92, v93
  v_or3_b32 v224, v224, v94, v95
  v_or_b32 v224, v224, v225
  v_cmp_ne_u32 vcc, 0, v224
  s_cbranch_vccnz L_qr
  v_pk_add_f32 v[224:225], v[128:129], v[132:133]
  v_pk_add_f32 v[226:227], v[136:137], v[140:141]
  v_pk_add_f32 v[228:229], v[144:145], v[148:149]
  v_pk_add_f32 v[230:231], v[152:153], v[156:157]
  v_pk_add_f32 v[224:225], v[224:225], v[226:227]
  v_pk_add_f32 v[228:229], v[228:229], v[230:231]
  v_pk_add_f32 v[224:225], v[224:225], v[228:229]
  v_cvt_pk_bf16_f32 v240, v224, v225
  ds_write_b32 v15, v240 offset:4096
L_qj0:
  s_mov_b32 s42, 106496
  buffer_load_dwordx4 v[212:215], v2, s[4:7], s42 offen offset:0 nt
  s_mov_b32 s42, 114688
  buffer_load_dwordx4 v[216:219], v2, s[4:7], s42 offen offset:0 nt
  s_mov_b32 s42, 122880
  buffer_load_dwordx4 v[220:223], v2, s[4:7], s42 offen offset:0 nt
  s_waitcnt lgkmcnt(0)
  s_barrier
  ds_read_b32 v243, v33 offset:6240
  ds_read_b128 v[4:7], v242 offset:4096
  s_waitcnt lgkmcnt(0)
  v_cmp_ne_u32 vcc, 0, v243
  s_cbranch_vccnz L_qfb
L_qokP:
  v_dot2_f32_bf16 v40, v160, v4, 0
  v_dot2_f32_bf16 v40, v161, v5, v40
  v_dot2_f32_bf16 v40, v162, v6, v40
  v_dot2_f32_bf16 v40, v163, v7, v40
  v_dot2_f32_bf16 v41, v164, v4, 0
  v_dot2_f32_bf16 v41, v165, v5, v41
  v_dot2_f32_bf16 v41, v166, v6, v41
  v_dot2_f32_bf16 v41, v167, v7, v41
  buffer_store_dword v24, v248, s[24:27], 0 offen sc1
  buffer_store_dwordx4 v[24:27], v249, s[24:27], 0 offen sc1
  s_lshl_b32 s43, s39, 3
  s_add_u32 s43, s43, s38
  s_lshl_b32 s43, s43, 3
  s_add_u32 s43, s43, 159744
  s_bitcmp1_b32 s101, 0
  s_cselect_b32 s43, 2147483632, s43
  s_mov_b64 exec, 1
  buffer_store_dwordx2 v[28:29], v33, s[24:27], s43 offen sc1
  s_mov_b64 exec, -1
  v_dot2_f32_bf16 v42, v168, v4, 0
  v_dot2_f32_bf16 v42, v169, v5, v42
  v_dot2_f32_bf16 v42, v170, v6, v42
  v_dot2_f32_bf16 v42, v171, v7, v42
  v_dot2_f32_bf16 v43, v172, v4, 0
  v_dot2_f32_bf16 v43, v173, v5, v43
  v_dot2_f32_bf16 v43, v174, v6, v43
  v_dot2_f32_bf16 v43, v175, v7, v43
  v_dot2_f32_bf16 v44, v176, v4, 0
  v_dot2_f32_bf16 v44, v177, v5, v44
  v_dot2_f32_bf16 v44, v178, v6, v44
  v_dot2_f32_bf16 v44, v179, v7, v44
  v_dot2_f32_bf16 v45, v180, v4, 0
  v_dot2_f32_bf16 v45, v181, v5, v45
  v_dot2_f32_bf16 v45, v182, v6, v45
  v_dot2_f32_bf16 v45, v183, v7, v45
  v_dot2_f32_bf16 v46, v184, v4, 0
  v_dot2_f32_bf16 v46, v185, v5, v46
  v_dot2_f32_bf16 v46, v186, v6, v46
  v_dot2_f32_bf16 v46, v187, v7, v46
  v_dot2_f32_bf16 v47, v188, v4, 0
  v_dot2_f32_bf16 v47, v189, v5, v47
  v_dot2_f32_bf16 v47, v190, v6, v47
  v_dot2_f32_bf16 v47, v191, v7, v47
  s_lshl_b32 s47, s90, 10
  s_add_u32 s43, s47, s91
  s_mul_i32 s47, s90, s46
  s_bitcmp1_b32 s37, s98
  s_cselect_b32 m0, s43, s36
  s_cselect_b32 s22, s60, 0
  s_cselect_b32 s43, 1, 0
  buffer_load_dwordx4 v39, s[20:23], s47 offen  lds
  s_add_u32 s90, s90, s43
  v_dot2_f32_bf16 v48, v192, v4, 0
  v_dot2_f32_bf16 v48, v193, v5, v48
  v_dot2_f32_bf16 v48, v194, v6, v48
  v_dot2_f32_bf16 v48, v195, v7, v48
  s_waitcnt vmcnt(10)
  v_dot2_f32_bf16 v49, v196, v4, 0
  v_dot2_f32_bf16 v49, v197, v5, v49
  v_dot2_f32_bf16 v49, v198, v6, v49
  v_dot2_f32_bf16 v49, v199, v7, v49
  s_waitcnt vmcnt(9)
  v_dot2_f32_bf16 v50, v200, v4, 0
  v_dot2_f32_bf16 v50, v201, v5, v50
  v_dot2_f32_bf16 v50, v202, v6, v50
  v_dot2_f32_bf16 v50, v203, v7, v50
  s_waitcnt vmcnt(8)
  v_dot2_f32_bf16 v51, v204, v4, 0
  v_dot2_f32_bf16 v51, v205, v5, v51
  v_dot2_f32_bf16 v51, v206, v6, v51
  v_dot2_f32_bf16 v51, v207, v7, v51
  s_waitcnt vmcnt(7)
  s_mov_b32 s42, 131072
  buffer_load_dwordx4 v[160:163], v2, s[4:7], s42 offen offset:0 nt
  v_dot2_f32_bf16 v52, v208, v4, 0
  v_dot2_f32_bf16 v52, v209, v5, v52
  v_dot2_f32_bf16 v52, v210, v6, v52
  v_dot2_f32_bf16 v52, v211, v7, v52
  s_waitcnt vmcnt(7)
  s_mov_b32 s42, 139264
  buffer_load_dwordx4 v[164:167], v2, s[4:7], s42 offen offset:0 nt
  v_dot2_f32_bf16 v53, v212, v4, 0
  v_dot2_f32_bf16 v53, v213, v5, v53
  v_dot2_f32_bf16 v53, v214, v6, v53
  v_dot2_f32_bf16 v53, v215, v7, v53
  s_waitcnt vmcnt(7)
  s_mov_b32 s42, 147456
  buffer_load_dwordx4 v[168:171], v2, s[4:7], s42 offen offset:0 nt
  s_memrealtime s[94:95]
  ds_read_b32 v31, v33 offset:6208
  v_dot2_f32_bf16 v54, v216, v4, 0
  v_dot2_f32_bf16 v54, v217, v5, v54
  v_dot2_f32_bf16 v54, v218, v6, v54
  v_dot2_f32_bf16 v54, v219, v7, v54
  s_waitcnt vmcnt(7)
  v_dot2_f32_bf16 v55, v220, v4, 0
  v_dot2_f32_bf16 v55, v221, v5, v55
  v_dot2_f32_bf16 v55, v222, v6, v55
  v_dot2_f32_bf16 v55, v223, v7, v55
  s_waitcnt vmcnt(6)
  s_waitcnt vmcnt(5)
  s_waitcnt vmcnt(4)
  v_mov_b32 v228, 0
  v_mov_b32 v229, 1
  s_bitcmp1_b32 s101, 0
  s_cbranch_scc1 L_nocnt
  s_mov_b64 exec, 1
  global_atomic_add v228, v229, s[84:85] sc1
  s_mov_b64 exec, -1
L_nocnt:
  v_add_f32_dpp v40, v40, v40 row_shl:8 row_mask:0xf bank_mask:0x3
  v_add_f32_dpp v41, v41, v41 row_shl:8 row_mask:0xf bank_mask:0x3
  v_add_f32_dpp v42, v42, v42 row_shl:8 row_mask:0xf bank_mask:0x3
  v_add_f32_dpp v43, v43, v43 row_shl:8 row_mask:0xf bank_mask:0x3
  v_add_f32_dpp v44, v44, v44 row_shl:8 row_mask:0xf bank_mask:0x3
  v_add_f32_dpp v45, v45, v45 row_shl:8 row_mask:0xf bank_mask:0x3
  v_add_f32_dpp v46, v46, v46 row_shl:8 row_mask:0xf bank_mask:0x3
  v_add_f32_dpp v47, v47, v47 row_shl:8 row_mask:0xf bank_mask:0x3
  v_add_f32_dpp v40, v48, v48 row_shr:8 row_mask:0xf bank_mask:0xc
  v_add_f32_dpp v41, v49, v49 row_shr:8 row_mask:0xf bank_mask:0xc
  v_add_f32_dpp v42, v50, v50 row_shr:8 row_mask:0xf bank_mask:0xc
  v_add_f32_dpp v43, v51, v51 row_shr:8 row_mask:0xf bank_mask:0xc
  v_add_f32_dpp v44, v52, v52 row_shr:8 row_mask:0xf bank_mask:0xc
  v_add_f32_dpp v45, v53, v53 row_shr:8 row_mask:0xf bank_mask:0xc
  v_add_f32_dpp v46, v54, v54 row_shr:8 row_mask:0xf bank_mask:0xc
  v_add_f32_dpp v47, v55, v55 row_shr:8 row_mask:0xf bank_mask:0xc
  v_add_f32_dpp v40, v40, v40 row_shl:4 row_mask:0xf bank_mask:0x5
  v_add_f32_dpp v41, v41, v41 row_shl:4 row_mask:0xf bank_mask:0x5
  v_add_f32_dpp v42, v42, v42 row_shl:4 row_mask:0xf bank_mask:0x5
  v_add_f32_dpp v43, v43, v43 row_shl:4 row_mask:0xf bank_mask:0x5
  v_add_f32_dpp v40, v44, v44 row_shr:4 row_mask:0xf bank_mask:0xa
  v_add_f32_dpp v41, v45, v45 row_shr:4 row_mask:0xf bank_mask:0xa
  v_add_f32_dpp v42, v46, v46 row_shr:4 row_mask:0xf bank_mask:0xa
  v_add_f32_dpp v43, v47, v47 row_shr:4 row_mask:0xf bank_mask:0xa
  v_add_f32_dpp v40, v40, v40 quad_perm:[2,3,0,1] row_mask:0xf bank_mask:0xf
  v_add_f32_dpp v41, v41, v41 quad_perm:[2,3,0,1] row_mask:0xf bank_mask:0xf
  v_add_f32_dpp v42, v42, v42 quad_perm:[2,3,0,1] row_mask:0xf bank_mask:0xf
  v_add_f32_dpp v43, v43, v43 quad_perm:[2,3,0,1] row_mask:0xf bank_mask:0xf
  v_cndmask_b32 v40, v40, v42, s[50:51]
  v_cndmask_b32 v41, v41, v43, s[50:51]
  s_nop 0
  v_add_f32_dpp v40, v40, v40 quad_perm:[1,0,3,2] row_mask:0xf bank_mask:0xf
  v_add_f32_dpp v41, v41, v41 quad_perm:[1,0,3,2] row_mask:0xf bank_mask:0xf
  v_mov_b32 v56, v57
  v_mov_b32 v57, v58
  v_mov_b32 v58, v59
  v_mov_b32 v59, v60
  v_mov_b32 v60, v61
  v_mov_b32 v61, v62
  v_mov_b32 v62, v63
  v_cndmask_b32 v40, v40, v41, s[52:53]
  v_cvt_pk_bf16_f32 v40, 0, v40
  v_mul_f32 v40, s54, v40
  v_cvt_pk_bf16_f32 v63, 0, v40
  s_cmp_eq_u32 s44, 1
  s_cselect_b32 s42, 4, 3
  v_bfe_u32 v226, v0, 4, 2
  v_bfe_u32 v227, v0, 2, 2
  v_lshl_add_u32 v226, v226, s42, v227
  s_add_u32 s42, s14, 4
  v_lshlrev_b32 v226, s42, v226
  v_and_b32 v227, 3, v0
  v_lshl_add_u32 v226, v227, 3, v226
  v_add_u32 v124, s91, v226
  s_mov_b32 s13, 70
  s_mov_b32 s14, -20
  s_mov_b32 s15, -120
  s_mov_b32 s40, 0
  s_mov_b32 s98, 0
  s_mov_b32 s99, 3
  s_mov_b32 s18, s6
  s_mov_b32 s19, s7
  s_mov_b32 s92, 0
  s_getreg_b32 s42, hwreg(HW_REG_XCC_ID)
  s_bitcmp1_b32 s42, 0
  s_cselect_b32 s42, 60, 0
  s_cselect_b32 s59, 0, 0
  s_sub_u32 s92, s92, s42
  s_add_u32 s92, s92, 480
  s_waitcnt lgkmcnt(0)
  v_readfirstlane_b32 s63, v31
  s_sub_u32 s93, s94, s92
  s_sub_u32 s43, s63, s93
  s_cmp_eq_u32 s63, 0x80000000
  s_cselect_b32 s43, 0, s43
  s_cselect_b32 s96, s61, 3
  s_cmp_gt_i32 s43, s13
  s_cselect_b32 s96, 2, s96
  s_cmp_lt_i32 s43, s14
  s_cselect_b32 s96, 4, s96
  s_cmp_lt_i32 s43, s15
  s_cselect_b32 s96, 6, s96
  s_branch L_k0_next
L_pump:
  s_waitcnt vmcnt(3)
  s_mov_b32 s42, 40960
  buffer_load_dwordx4 v[180:183], v2, s[4:7], s42 offen offset:0 nt
  s_waitcnt vmcnt(3)
  s_mov_b32 s42, 49152
  buffer_load_dwordx4 v[184:187], v2, s[4:7], s42 offen offset:0 nt
  s_waitcnt vmcnt(3)
  s_mov_b32 s42, 57344
  buffer_load_dwordx4 v[188:191], v2, s[4:7], s42 offen offset:0 nt
  s_waitcnt vmcnt(3)
  s_mov_b32 s42, 65536
  buffer_load_dwordx4 v[192:195], v2, s[4:7], s42 offen offset:0 nt
  s_waitcnt vmcnt(3)
  s_mov_b32 s42, 73728
  buffer_load_dwordx4 v[196:199], v2, s[4:7], s42 offen offset:0 nt
  s_waitcnt vmcnt(3)
  s_mov_b32 s42, 81920
  buffer_load_dwordx4 v[200:203], v2, s[4:7], s42 offen offset:0 nt
  s_waitcnt vmcnt(3)
  s_mov_b32 s42, 90112
  buffer_load_dwordx4 v[204:207], v2, s[4:7], s42 offen offset:0 nt
  s_waitcnt vmcnt(3)
  s_mov_b32 s42, 98304
  buffer_load_dwordx4 v[208:211], v2, s[4:7], s42 offen offset:0 nt
  s_waitcnt vmcnt(3)
  s_mov_b32 s42, 106496
  buffer_load_dwordx4 v[212:215], v2, s[4:7], s42 offen offset:0 nt
  s_waitcnt vmcnt(3)
  s_mov_b32 s42, 114688
  buffer_load_dwordx4 v[216:219], v2, s[4:7], s42 offen offset:0 nt
  s_waitcnt vmcnt(3)
  s_mov_b32 s42, 122880
  buffer_load_dwordx4 v[220:223], v2, s[4:7], s42 offen offset:0 nt
  s_waitcnt vmcnt(3)
  s_mov_b32 s42, 131072
  buffer_load_dwordx4 v[128:131], v2, s[4:7], s42 offen offset:0 nt
  s_waitcnt vmcnt(3)
  s_mov_b32 s42, 139264
  buffer_load_dwordx4 v[132:135], v2, s[4:7], s42 offen offset:0 nt
  s_waitcnt lgkmcnt(0)
  s_barrier
  ds_read_b32 v243, v33 offset:6240
  ds_read_b128 v[4:7], v242 offset:4096
  s_waitcnt lgkmcnt(0)
  v_cmp_ne_u32 vcc, 0, v243
  s_cbranch_vccnz L_qfb
L_qokU:
  v_dot2_f32_bf16 v40, v160, v4, 0
  v_dot2_f32_bf16 v40, v161, v5, v40
  v_dot2_f32_bf16 v40, v162, v6, v40
  v_dot2_f32_bf16 v40, v163, v7, v40
  v_dot2_f32_bf16 v41, v164, v4, 0
  v_dot2_f32_bf16 v41, v165, v5, v41
  v_dot2_f32_bf16 v41, v166, v6, v41
  v_dot2_f32_bf16 v41, v167, v7, v41
  v_dot2_f32_bf16 v42, v168, v4, 0
  v_dot2_f32_bf16 v42, v169, v5, v42
  v_dot2_f32_bf16 v42, v170, v6, v42
  v_dot2_f32_bf16 v42, v171, v7, v42
  v_dot2_f32_bf16 v43, v172, v4, 0
  v_dot2_f32_bf16 v43, v173, v5, v43
  v_dot2_f32_bf16 v43, v174, v6, v43
  v_dot2_f32_bf16 v43, v175, v7, v43
  v_dot2_f32_bf16 v44, v176, v4, 0
  v_dot2_f32_bf16 v44, v177, v5, v44
  v_dot2_f32_bf16 v44, v178, v6, v44
  v_dot2_f32_bf16 v44, v179, v7, v44
  v_dot2_f32_bf16 v45, v180, v4, 0
  v_dot2_f32_bf16 v45, v181, v5, v45
  v_dot2_f32_bf16 v45, v182, v6, v45
  v_dot2_f32_bf16 v45, v183, v7, v45
  v_dot2_f32_bf16 v46, v184, v4, 0
  v_dot2_f32_bf16 v46, v185, v5, v46
  v_dot2_f32_bf16 v46, v186, v6, v46
  v_dot2_f32_bf16 v46, v187, v7, v46
  v_dot2_f32_bf16 v47, v188, v4, 0
  v_dot2_f32_bf16 v47, v189, v5, v47
  v_dot2_f32_bf16 v47, v190, v6, v47
  v_dot2_f32_bf16 v47, v191, v7, v47
  s_lshl_b32 s47, s90, 10
  s_add_u32 s43, s47, s91
  s_mul_i32 s47, s90, s46
  s_bitcmp1_b32 s37, s98
  s_cselect_b32 m0, s43, s36
  s_cselect_b32 s22, s60, 0
  s_cselect_b32 s43, 1, 0
  buffer_load_dwordx4 v39, s[20:23], s47 offen  lds
  s_add_u32 s90, s90, s43
  v_dot2_f32_bf16 v48, v192, v4, 0
  v_dot2_f32_bf16 v48, v193, v5, v48
  v_dot2_f32_bf16 v48, v194, v6, v48
  v_dot2_f32_bf16 v48, v195, v7, v48
  v_dot2_f32_bf16 v49, v196, v4, 0
  v_dot2_f32_bf16 v49, v197, v5, v49
  v_dot2_f32_bf16 v49, v198, v6, v49
  v_dot2_f32_bf16 v49, v199, v7, v49
  v_dot2_f32_bf16 v50, v200, v4, 0
  v_dot2_f32_bf16 v50, v201, v5, v50
  v_dot2_f32_bf16 v50, v202, v6, v50
  v_dot2_f32_bf16 v50, v203, v7, v50
  v_dot2_f32_bf16 v51, v204, v4, 0
  v_dot2_f32_bf16 v51, v205, v5, v51
  v_dot2_f32_bf16 v51, v206, v6, v51
  v_dot2_f32_bf16 v51, v207, v7, v51
  v_dot2_f32_bf16 v52, v208, v4, 0
  v_dot2_f32_bf16 v52, v209, v5, v52
  v_dot2_f32_bf16 v52, v210, v6, v52
  v_dot2_f32_bf16 v52, v211, v7, v52
  v_dot2_f32_bf16 v53, v212, v4, 0
  v_dot2_f32_bf16 v53, v213, v5, v53
  v_dot2_f32_bf16 v53, v214, v6, v53
  v_dot2_f32_bf16 v53, v215, v7, v53
  s_waitcnt vmcnt(4)
  s_mov_b32 s42, 147456
  buffer_load_dwordx4 v[160:163], v2, s[4:7], s42 offen offset:0 nt
  s_memrealtime s[94:95]
  ds_read_b32 v31, v33 offset:6208
  v_dot2_f32_bf16 v54, v216, v4, 0
  v_dot2_f32_bf16 v54, v217, v5, v54
  v_dot2_f32_bf16 v54, v218, v6, v54
  v_dot2_f32_bf16 v54, v219, v7, v54
  s_waitcnt vmcnt(4)
  s_mov_b32 s42, 155648
  buffer_load_dwordx4 v[164:167], v2, s[4:7], s42 offen offset:0 nt
  v_dot2_f32_bf16 v55, v220, v4, 0
  v_dot2_f32_bf16 v55, v221, v5, v55
  v_dot2_f32_bf16 v55, v222, v6, v55
  v_dot2_f32_bf16 v55, v223, v7, v55
  v_add_f32_dpp v40, v40, v40 row_shl:8 row_mask:0xf bank_mask:0x3
  v_add_f32_dpp v41, v41, v41 row_shl:8 row_mask:0xf bank_mask:0x3
  v_add_f32_dpp v42, v42, v42 row_shl:8 row_mask:0xf bank_mask:0x3
  v_add_f32_dpp v43, v43, v43 row_shl:8 row_mask:0xf bank_mask:0x3
  v_add_f32_dpp v44, v44, v44 row_shl:8 row_mask:0xf bank_mask:0x3
  v_add_f32_dpp v45, v45, v45 row_shl:8 row_mask:0xf bank_mask:0x3
  v_add_f32_dpp v46, v46, v46 row_shl:8 row_mask:0xf bank_mask:0x3
  v_add_f32_dpp v47, v47, v47 row_shl:8 row_mask:0xf bank_mask:0x3
  v_add_f32_dpp v40, v48, v48 row_shr:8 row_mask:0xf bank_mask:0xc
  v_add_f32_dpp v41, v49, v49 row_shr:8 row_mask:0xf bank_mask:0xc
  v_add_f32_dpp v42, v50, v50 row_shr:8 row_mask:0xf bank_mask:0xc
  v_add_f32_dpp v43, v51, v51 row_shr:8 row_mask:0xf bank_mask:0xc
  v_add_f32_dpp v44, v52, v52 row_shr:8 row_mask:0xf bank_mask:0xc
  v_add_f32_dpp v45, v53, v53 row_shr:8 row_mask:0xf bank_mask:0xc
  v_add_f32_dpp v46, v54, v54 row_shr:8 row_mask:0xf bank_mask:0xc
  v_add_f32_dpp v47, v55, v55 row_shr:8 row_mask:0xf bank_mask:0xc
  v_add_f32_dpp v40, v40, v40 row_shl:4 row_mask:0xf bank_mask:0x5
  v_add_f32_dpp v41, v41, v41 row_shl:4 row_mask:0xf bank_mask:0x5
  v_add_f32_dpp v42, v42, v42 row_shl:4 row_mask:0xf bank_mask:0x5
  v_add_f32_dpp v43, v43, v43 row_shl:4 row_mask:0xf bank_mask:0x5
  v_add_f32_dpp v40, v44, v44 row_shr:4 row_mask:0xf bank_mask:0xa
  v_add_f32_dpp v41, v45, v45 row_shr:4 row_mask:0xf bank_mask:0xa
  v_add_f32_dpp v42, v46, v46 row_shr:4 row_mask:0xf bank_mask:0xa
  v_add_f32_dpp v43, v47, v47 row_shr:4 row_mask:0xf bank_mask:0xa
  v_add_f32_dpp v40, v40, v40 quad_perm:[2,3,0,1] row_mask:0xf bank_mask:0xf
  v_add_f32_dpp v41, v41, v41 quad_perm:[2,3,0,1] row_mask:0xf bank_mask:0xf
  v_add_f32_dpp v42, v42, v42 quad_perm:[2,3,0,1] row_mask:0xf bank_mask:0xf
  v_add_f32_dpp v43, v43, v43 quad_perm:[2,3,0,1] row_mask:0xf bank_mask:0xf
  v_cndmask_b32 v40, v40, v42, s[50:51]
  v_cndmask_b32 v41, v41, v43, s[50:51]
  s_nop 0
  v_add_f32_dpp v40, v40, v40 quad_perm:[1,0,3,2] row_mask:0xf bank_mask:0xf
  v_add_f32_dpp v41, v41, v41 quad_perm:[1,0,3,2] row_mask:0xf bank_mask:0xf
  v_mov_b32 v56, v57
  v_mov_b32 v57, v58
  v_mov_b32 v58, v59
  v_mov_b32 v59, v60
  v_mov_b32 v60, v61
  v_mov_b32 v61, v62
  v_mov_b32 v62, v63
  v_cndmask_b32 v40, v40, v41, s[52:53]
  v_cvt_pk_bf16_f32 v40, 0, v40
  v_mul_f32 v40, s54, v40
  v_cvt_pk_bf16_f32 v63, 0, v40
  s_cmp_eq_u32 s44, 1
  s_cselect_b32 s42, 4, 3
  v_bfe_u32 v226, v0, 4, 2
  v_bfe_u32 v227, v0, 2, 2
  v_lshl_add_u32 v226, v226, s42, v227
  s_add_u32 s42, s14, 4
  v_lshlrev_b32 v226, s42, v226
  v_and_b32 v227, 3, v0
  v_lshl_add_u32 v226, v227, 3, v226
  v_add_u32 v124, s91, v226
  s_mov_b32 s13, 70
  s_mov_b32 s14, -20
  s_mov_b32 s15, -120
  s_mov_b32 s40, 0
  s_mov_b32 s98, 0
  s_mov_b32 s99, 3
  s_mov_b32 s18, s6
  s_mov_b32 s19, s7
  s_mov_b32 s92, 0
  s_getreg_b32 s42, hwreg(HW_REG_XCC_ID)
  s_bitcmp1_b32 s42, 0
  s_cselect_b32 s42, 60, 0
  s_cselect_b32 s59, 0, 0
  s_sub_u32 s92, s92, s42
  s_add_u32 s92, s92, 480
  s_waitcnt lgkmcnt(0)
  v_readfirstlane_b32 s63, v31
  s_sub_u32 s93, s94, s92
  s_sub_u32 s43, s63, s93
  s_cmp_eq_u32 s63, 0x80000000
  s_cselect_b32 s43, 0, s43
  s_cselect_b32 s96, s61, 3
  s_cmp_gt_i32 s43, s13
  s_cselect_b32 s96, 2, s96
  s_cmp_lt_i32 s43, s14
  s_cselect_b32 s96, 4, s96
  s_cmp_lt_i32 s43, s15
  s_cselect_b32 s96, 6, s96
  s_mov_b32 s40, 131072
  s_mov_b32 s98, 1
  s_waitcnt vmcnt(4)
  s_mov_b32 s42, 163840
  buffer_load_dwordx4 v[168:171], v2, s[4:7], s42 offen offset:0 nt
  s_lshl_b32 s47, s90, 10
  s_add_u32 s43, s47, s91
  s_mul_i32 s47, s90, s46
  s_bitcmp1_b32 s37, s98
  s_cselect_b32 m0, s43, s36
  s_cselect_b32 s22, s60, 0
  s_cselect_b32 s43, 1, 0
  buffer_load_dwordx4 v39, s[20:23], s47 offen  lds
  s_add_u32 s90, s90, s43
  s_and_b32 s43, s98, 7
  s_cmp_lg_u32 s43, s3
  s_cbranch_scc1 L_c0_1
  v_mov_b32 v32, s93
  s_mov_b32 s62, s93
  s_mul_i32 s47, s98, 8192
  buffer_store_dword v32, v36, s[24:27], s47 offen sc1
  s_lshr_b32 s43, s2, 3
  s_mul_i32 s47, s98, 5
  s_add_u32 s43, s43, s47
  s_and_b32 s43, s43, 3
  s_mul_i32 s43, s43, 2048
  s_add_u32 s43, s43, 1048576
  s_sub_u32 s47, s98, 1
  s_max_i32 s47, s47, 0
  s_mul_i32 s47, s47, 8192
  s_add_u32 s43, s43, s47
  buffer_load_dword v34, v35, s[24:27], s43 offen
L_c0_1:
  v_dot2_f32_bf16 v40, v128, v4, 0
  v_dot2_f32_bf16 v40, v129, v5, v40
  v_dot2_f32_bf16 v40, v130, v6, v40
  v_dot2_f32_bf16 v40, v131, v7, v40
  s_waitcnt vmcnt(5)
  s_mov_b32 s42, 172032
  buffer_load_dwordx4 v[172:175], v2, s[4:7], s42 offen offset:0 nt
  v_dot2_f32_bf16 v41, v132, v4, 0
  v_dot2_f32_bf16 v41, v133, v5, v41
  v_dot2_f32_bf16 v41, v134, v6, v41
  v_dot2_f32_bf16 v41, v135, v7, v41
  s_waitcnt vmcnt(4)
  s_mov_b32 s42, 180224
  buffer_load_dwordx4 v[176:179], v2, s[4:7], s42 offen offset:0 nt
  v_dot2_f32_bf16 v42, v160, v4, 0
  v_dot2_f32_bf16 v42, v161, v5, v42
  v_dot2_f32_bf16 v42, v162, v6, v42
  v_dot2_f32_bf16 v42, v163, v7, v42
  s_waitcnt vmcnt(4)
  s_mov_b32 s42, 188416
  buffer_load_dwordx4 v[180:183], v2, s[4:7], s42 offen offset:0 nt
  v_dot2_f32_bf16 v43, v164, v4, 0
  v_dot2_f32_bf16 v43, v165, v5, v43
  v_dot2_f32_bf16 v43, v166, v6, v43
  v_dot2_f32_bf16 v43, v167, v7, v43
  s_waitcnt vmcnt(4)
  s_mov_b32 s42, 196608
  buffer_load_dwordx4 v[184:187], v2, s[4:7], s42 offen offset:0 nt
  v_dot2_f32_bf16 v44, v168, v4, 0
  v_dot2_f32_bf16 v44, v169, v5, v44
  v_dot2_f32_bf16 v44, v170, v6, v44
  v_dot2_f32_bf16 v44, v171, v7, v44
  s_waitcnt vmcnt(3)
  s_mov_b32 s42, 204800
  buffer_load_dwordx4 v[188:191], v2, s[4:7], s42 offen offset:0 nt
  v_dot2_f32_bf16 v45, v172, v4, 0
  v_dot2_f32_bf16 v45, v173, v5, v45
  v_dot2_f32_bf16 v45, v174, v6, v45
  v_dot2_f32_bf16 v45, v175, v7, v45
  s_waitcnt vmcnt(3)
  s_mov_b32 s42, 212992
  buffer_load_dwordx4 v[192:195], v2, s[4:7], s42 offen offset:0 nt
  v_dot2_f32_bf16 v46, v176, v4, 0
  v_dot2_f32_bf16 v46, v177, v5, v46
  v_dot2_f32_bf16 v46, v178, v6, v46
  v_dot2_f32_bf16 v46, v179, v7, v46
  s_waitcnt vmcnt(3)
  s_mov_b32 s42, 221184
  buffer_load_dwordx4 v[196:199], v2, s[4:7], s42 offen offset:0 nt
  v_dot2_f32_bf16 v47, v180, v4, 0
  v_dot2_f32_bf16 v47, v181, v5, v47
  v_dot2_f32_bf16 v47, v182, v6, v47
  v_dot2_f32_bf16 v47, v183, v7, v47
  s_waitcnt vmcnt(3)
  s_mov_b32 s42, 229376
  buffer_load_dwordx4 v[200:203], v2, s[4:7], s42 offen offset:0 nt
  v_dot2_f32_bf16 v48, v184, v4, 0
  v_dot2_f32_bf16 v48, v185, v5, v48
  v_dot2_f32_bf16 v48, v186, v6, v48
  v_dot2_f32_bf16 v48, v187, v7, v48
  s_waitcnt vmcnt(3)
  s_mov_b32 s42, 237568
  buffer_load_dwordx4 v[204:207], v2, s[4:7], s42 offen offset:0 nt
  v_dot2_f32_bf16 v49, v188, v4, 0
  v_dot2_f32_bf16 v49, v189, v5, v49
  v_dot2_f32_bf16 v49, v190, v6, v49
  v_dot2_f32_bf16 v49, v191, v7, v49
  s_waitcnt vmcnt(3)
  s_mov_b32 s42, 245760
  buffer_load_dwordx4 v[208:211], v2, s[4:7], s42 offen offset:0 nt
  v_dot2_f32_bf16 v50, v192, v4, 0
  v_dot2_f32_bf16 v50, v193, v5, v50
  v_dot2_f32_bf16 v50, v194, v6, v50
  v_dot2_f32_bf16 v50, v195, v7, v50
  s_waitcnt vmcnt(3)
  s_mov_b32 s42, 253952
  buffer_load_dwordx4 v[212:215], v2, s[4:7], s42 offen offset:0 nt
  v_dot2_f32_bf16 v51, v196, v4, 0
  v_dot2_f32_bf16 v51, v197, v5, v51
  v_dot2_f32_bf16 v51, v198, v6, v51
  v_dot2_f32_bf16 v51, v199, v7, v51
  s_waitcnt vmcnt(3)
  s_mov_b32 s42, 262144
  buffer_load_dwordx4 v[160:163], v2, s[4:7], s42 offen offset:0 nt
  v_dot2_f32_bf16 v52, v200, v4, 0
  v_dot2_f32_bf16 v52, v201, v5, v52
  v_dot2_f32_bf16 v52, v202, v6, v52
  v_dot2_f32_bf16 v52, v203, v7, v52
  s_waitcnt vmcnt(3)
  s_mov_b32 s42, 270336
  buffer_load_dwordx4 v[164:167], v2, s[4:7], s42 offen offset:0 nt
  s_and_b32 s43, s98, 7
  s_cmp_lg_u32 s43, s3
  s_cbranch_scc1 L_c1_2
  v_subrev_u32 v34, s62, v34
  v_add_u32 v32, 0x1000, v34
  v_cmp_gt_u32 vcc, 0x2000, v32
  s_nop 1
  v_cndmask_b32 v34, 0, v34, vcc
  s_nop 1
  v_add_u32_dpp v34, v34, v34 row_ror:8 row_mask:0xf bank_mask:0xf
  s_nop 1
  v_add_u32_dpp v34, v34, v34 row_ror:4 row_mask:0xf bank_mask:0xf
  s_nop 1
  v_add_u32_dpp v34, v34, v34 row_ror:2 row_mask:0xf bank_mask:0xf
  s_nop 1
  v_add_u32_dpp v34, v34, v34 row_ror:1 row_mask:0xf bank_mask:0xf
  s_nop 0
  v_readlane_b32 s43, v34, 0
  s_nop 0
  s_ashr_i32 s43, s43, 3
  s_add_u32 s43, s43, s62
  v_mov_b32 v32, s43
  ds_write_b32 v33, v32 offset:6208
L_c1_2:
  v_dot2_f32_bf16 v53, v204, v4, 0
  v_dot2_f32_bf16 v53, v205, v5, v53
  v_dot2_f32_bf16 v53, v206, v6, v53
  v_dot2_f32_bf16 v53, v207, v7, v53
  s_waitcnt vmcnt(3)
  s_mov_b32 s42, 278528
  buffer_load_dwordx4 v[168:171], v2, s[4:7], s42 offen offset:0 nt
  s_memrealtime s[94:95]
  ds_read_b32 v31, v33 offset:6208
  v_dot2_f32_bf16 v54, v208, v4, 0
  v_dot2_f32_bf16 v54, v209, v5, v54
  v_dot2_f32_bf16 v54, v210, v6, v54
  v_dot2_f32_bf16 v54, v211, v7, v54
  s_waitcnt vmcnt(3)
  v_dot2_f32_bf16 v55, v212, v4, 0
  v_dot2_f32_bf16 v55, v213, v5, v55
  v_dot2_f32_bf16 v55, v214, v6, v55
  v_dot2_f32_bf16 v55, v215, v7, v55
  v_add_f32_dpp v40, v40, v40 row_shl:8 row_mask:0xf bank_mask:0x3
  v_add_f32_dpp v41, v41, v41 row_shl:8 row_mask:0xf bank_mask:0x3
  v_add_f32_dpp v42, v42, v42 row_shl:8 row_mask:0xf bank_mask:0x3
  v_add_f32_dpp v43, v43, v43 row_shl:8 row_mask:0xf bank_mask:0x3
  v_add_f32_dpp v44, v44, v44 row_shl:8 row_mask:0xf bank_mask:0x3
  v_add_f32_dpp v45, v45, v45 row_shl:8 row_mask:0xf bank_mask:0x3
  v_add_f32_dpp v46, v46, v46 row_shl:8 row_mask:0xf bank_mask:0x3
  v_add_f32_dpp v47, v47, v47 row_shl:8 row_mask:0xf bank_mask:0x3
  v_add_f32_dpp v40, v48, v48 row_shr:8 row_mask:0xf bank_mask:0xc
  v_add_f32_dpp v41, v49, v49 row_shr:8 row_mask:0xf bank_mask:0xc
  v_add_f32_dpp v42, v50, v50 row_shr:8 row_mask:0xf bank_mask:0xc
  v_add_f32_dpp v43, v51, v51 row_shr:8 row_mask:0xf bank_mask:0xc
  v_add_f32_dpp v44, v52, v52 row_shr:8 row_mask:0xf bank_mask:0xc
  v_add_f32_dpp v45, v53, v53 row_shr:8 row_mask:0xf bank_mask:0xc
  v_add_f32_dpp v46, v54, v54 row_shr:8 row_mask:0xf bank_mask:0xc
  v_add_f32_dpp v47, v55, v55 row_shr:8 row_mask:0xf bank_mask:0xc
  v_add_f32_dpp v40, v40, v40 row_shl:4 row_mask:0xf bank_mask:0x5
  v_add_f32_dpp v41, v41, v41 row_shl:4 row_mask:0xf bank_mask:0x5
  v_add_f32_dpp v42, v42, v42 row_shl:4 row_mask:0xf bank_mask:0x5
  v_add_f32_dpp v43, v43, v43 row_shl:4 row_mask:0xf bank_mask:0x5
  v_add_f32_dpp v40, v44, v44 row_shr:4 row_mask:0xf bank_mask:0xa
  v_add_f32_dpp v41, v45, v45 row_shr:4 row_mask:0xf bank_mask:0xa
  v_add_f32_dpp v42, v46, v46 row_shr:4 row_mask:0xf bank_mask:0xa
  v_add_f32_dpp v43, v47, v47 row_shr:4 row_mask:0xf bank_mask:0xa
  v_add_f32_dpp v40, v40, v40 quad_perm:[2,3,0,1] row_mask:0xf bank_mask:0xf
  v_add_f32_dpp v41, v41, v41 quad_perm:[2,3,0,1] row_mask:0xf bank_mask:0xf
  v_add_f32_dpp v42, v42, v42 quad_perm:[2,3,0,1] row_mask:0xf bank_mask:0xf
  v_add_f32_dpp v43, v43, v43 quad_perm:[2,3,0,1] row_mask:0xf bank_mask:0xf
  v_cndmask_b32 v40, v40, v42, s[50:51]
  v_cndmask_b32 v41, v41, v43, s[50:51]
  s_nop 0
  v_add_f32_dpp v40, v40, v40 quad_perm:[1,0,3,2] row_mask:0xf bank_mask:0xf
  v_add_f32_dpp v41, v41, v41 quad_perm:[1,0,3,2] row_mask:0xf bank_mask:0xf
  v_mov_b32 v56, v57
  v_mov_b32 v57, v58
  v_mov_b32 v58, v59
  v_mov_b32 v59, v60
  v_mov_b32 v60, v61
  v_mov_b32 v61, v62
  v_mov_b32 v62, v63
  v_cndmask_b32 v40, v40, v41, s[52:53]
  v_cvt_pk_bf16_f32 v40, 0, v40
  v_mul_f32 v40, s54, v40
  v_cvt_pk_bf16_f32 v63, 0, v40
  s_add_u32 s92, s92, 480
  s_waitcnt lgkmcnt(0)
  v_readfirstlane_b32 s63, v31
  s_sub_u32 s93, s94, s92
  s_sub_u32 s43, s63, s93
  s_cmp_eq_u32 s63, 0x80000000
  s_cselect_b32 s43, 0, s43
  s_cselect_b32 s96, s61, 3
  s_cmp_gt_i32 s43, s13
  s_cselect_b32 s96, 2, s96
  s_cmp_lt_i32 s43, s14
  s_cselect_b32 s96, 4, s96
  s_cmp_lt_i32 s43, s15
  s_cselect_b32 s96, 6, s96
L_k0_next:
  s_add_u32 s40, s40, 131072
  s_add_u32 s98, s98, 1
  s_cmp_ge_u32 s40, 1048576
  s_cbranch_scc1 L_k_done
  s_add_u32 s97, s40, 131072
  s_cmp_eq_u32 s40, 917504
  s_cselect_b32 s97, 0, s97
  s_cselect_b32 s16, s8, s4
  s_cselect_b32 s17, s9, s5
  s_cmp_gt_u32 s99, 2
  s_cbranch_scc1 L_k0_u2
  s_cmp_le_u32 s96, 2
  s_cbranch_scc1 L_k0_u2
  s_add_u32 s42, s40, 16384
  buffer_load_dwordx4 v[168:171], v2, s[4:7], s42 offen offset:0 nt
L_k0_u2:
  s_cmp_gt_u32 s99, 3
  s_cbranch_scc1 L_k0_u3
  s_cmp_le_u32 s96, 3
  s_cbranch_scc1 L_k0_u3
  s_add_u32 s42, s40, 24576
  buffer_load_dwordx4 v[172:175], v2, s[4:7], s42 offen offset:0 nt
L_k0_u3:
  s_cmp_gt_u32 s99, 4
  s_cbranch_scc1 L_k0_u4
  s_cmp_le_u32 s96, 4
  s_cbranch_scc1 L_k0_u4
  s_add_u32 s42, s40, 32768
  buffer_load_dwordx4 v[176:179], v2, s[4:7], s42 offen offset:0 nt
L_k0_u4:
  s_cmp_gt_u32 s99, 5
  s_cbranch_scc1 L_k0_u5
  s_cmp_le_u32 s96, 5
  s_cbranch_scc1 L_k0_u5
  s_add_u32 s42, s40, 40960
  buffer_load_dwordx4 v[180:183], v2, s[4:7], s42 offen offset:0 nt
L_k0_u5:
  s_cmp_eq_u32 s96, 3
  s_cbranch_scc1 L_k0_b3
  s_cmp_eq_u32 s96, 4
  s_cbranch_scc1 L_k0_b4
  s_cmp_eq_u32 s96, 6
  s_cbranch_scc1 L_k0_b6
L_k0_b2:
  s_waitcnt vmcnt(1)
  s_cmp_gt_u32 s99, 2
  s_cbranch_scc1 L_k0_b2s2
  s_add_u32 s42, s40, 16384
  buffer_load_dwordx4 v[168:171], v2, s[4:7], s42 offen offset:0 nt
L_k0_b2s2:
  s_lshl_b32 s47, s90, 10
  s_add_u32 s43, s47, s91
  s_mul_i32 s47, s90, s46
  s_bitcmp1_b32 s37, s98
  s_cselect_b32 m0, s43, s36
  s_cselect_b32 s22, s60, 0
  s_cselect_b32 s43, 1, 0
  buffer_load_dwordx4 v39, s[20:23], s47 offen  lds
  s_add_u32 s90, s90, s43
  s_and_b32 s43, s98, 7
  s_cmp_lg_u32 s43, s3
  s_cbranch_scc1 L_c0_3
  v_mov_b32 v32, s93
  s_mov_b32 s62, s93
  s_mul_i32 s47, s98, 8192
  buffer_store_dword v32, v36, s[24:27], s47 offen sc1
  s_lshr_b32 s43, s2, 3
  s_mul_i32 s47, s98, 5
  s_add_u32 s43, s43, s47
  s_and_b32 s43, s43, 3
  s_mul_i32 s43, s43, 2048
  s_add_u32 s43, s43, 1048576
  s_sub_u32 s47, s98, 1
  s_max_i32 s47, s47, 0
  s_mul_i32 s47, s47, 8192
  s_add_u32 s43, s43, s47
  buffer_load_dword v34, v35, s[24:27], s43 offen
L_c0_3:
  v_dot2_f32_bf16 v40, v160, v4, 0
  v_dot2_f32_bf16 v40, v161, v5, v40
  v_dot2_f32_bf16 v40, v162, v6, v40
  v_dot2_f32_bf16 v40, v163, v7, v40
  s_waitcnt vmcnt(2)
  s_cmp_gt_u32 s99, 3
  s_cbranch_scc1 L_k0_b2s3
  s_add_u32 s42, s40, 24576
  buffer_load_dwordx4 v[172:175], v2, s[4:7], s42 offen offset:0 nt
L_k0_b2s3:
  v_dot2_f32_bf16 v41, v164, v4, 0
  v_dot2_f32_bf16 v41, v165, v5, v41
  v_dot2_f32_bf16 v41, v166, v6, v41
  v_dot2_f32_bf16 v41, v167, v7, v41
  s_waitcnt vmcnt(2)
  s_cmp_gt_u32 s99, 4
  s_cbranch_scc1 L_k0_b2s4
  s_add_u32 s42, s40, 32768
  buffer_load_dwordx4 v[176:179], v2, s[4:7], s42 offen offset:0 nt
L_k0_b2s4:
  s_memrealtime s[94:95]
  ds_read_b32 v31, v33 offset:6208
  v_dot2_f32_bf16 v42, v168, v4, 0
  v_dot2_f32_bf16 v42, v169, v5, v42
  v_dot2_f32_bf16 v42, v170, v6, v42
  v_dot2_f32_bf16 v42, v171, v7, v42
  s_waitcnt vmcnt(1)
  s_cmp_gt_u32 s99, 5
  s_cbranch_scc1 L_k0_b2s5
  s_add_u32 s42, s40, 40960
  buffer_load_dwordx4 v[180:183], v2, s[4:7], s42 offen offset:0 nt
L_k0_b2s5:
  v_dot2_f32_bf16 v43, v172, v4, 0
  v_dot2_f32_bf16 v43, v173, v5, v43
  v_dot2_f32_bf16 v43, v174, v6, v43
  v_dot2_f32_bf16 v43, v175, v7, v43
  s_add_u32 s92, s92, 120
  s_waitcnt lgkmcnt(0)
  v_readfirstlane_b32 s63, v31
  s_sub_u32 s93, s94, s92
  s_sub_u32 s43, s63, s93
  s_cmp_eq_u32 s63, 0x80000000
  s_cselect_b32 s43, 0, s43
  s_cselect_b32 s96, s61, 3
  s_cmp_gt_i32 s43, s13
  s_cselect_b32 s96, 2, s96
  s_cmp_lt_i32 s43, s14
  s_cselect_b32 s96, 4, s96
  s_cmp_lt_i32 s43, s15
  s_cselect_b32 s96, 6, s96
  s_mov_b32 s99, 2
  s_branch L_k1_next
L_k0_b3:
  s_waitcnt vmcnt(2)
  s_cmp_gt_u32 s99, 3
  s_cbranch_scc1 L_k0_b3s3
  s_add_u32 s42, s40, 24576
  buffer_load_dwordx4 v[172:175], v2, s[4:7], s42 offen offset:0 nt
L_k0_b3s3:
  s_lshl_b32 s47, s90, 10
  s_add_u32 s43, s47, s91
  s_mul_i32 s47, s90, s46
  s_bitcmp1_b32 s37, s98
  s_cselect_b32 m0, s43, s36
  s_cselect_b32 s22, s60, 0
  s_cselect_b32 s43, 1, 0
  buffer_load_dwordx4 v39, s[20:23], s47 offen  lds
  s_add_u32 s90, s90, s43
  s_and_b32 s43, s98, 7
  s_cmp_lg_u32 s43, s3
  s_cbranch_scc1 L_c0_4
  v_mov_b32 v32, s93
  s_mov_b32 s62, s93
  s_mul_i32 s47, s98, 8192
  buffer_store_dword v32, v36, s[24:27], s47 offen sc1
  s_lshr_b32 s43, s2, 3
  s_mul_i32 s47, s98, 5
  s_add_u32 s43, s43, s47
  s_and_b32 s43, s43, 3
  s_mul_i32 s43, s43, 2048
  s_add_u32 s43, s43, 1048576
  s_sub_u32 s47, s98, 1
  s_max_i32 s47, s47, 0
  s_mul_i32 s47, s47, 8192
  s_add_u32 s43, s43, s47
  buffer_load_dword v34, v35, s[24:27], s43 offen
L_c0_4:
  v_dot2_f32_bf16 v40, v160, v4, 0
  v_dot2_f32_bf16 v40, v161, v5, v40
  v_dot2_f32_bf16 v40, v162, v6, v40
  v_dot2_f32_bf16 v40, v163, v7, v40
  s_waitcnt vmcnt(3)
  s_cmp_gt_u32 s99, 4
  s_cbranch_scc1 L_k0_b3s4
  s_add_u32 s42, s40, 32768
  buffer_load_dwordx4 v[176:179], v2, s[4:7], s42 offen offset:0 nt
L_k0_b3s4:
  v_dot2_f32_bf16 v41, v164, v4, 0
  v_dot2_f32_bf16 v41, v165, v5, v41
  v_dot2_f32_bf16 v41, v166, v6, v41
  v_dot2_f32_bf16 v41, v167, v7, v41
  s_waitcnt vmcnt(3)
  s_cmp_gt_u32 s99, 5
  s_cbranch_scc1 L_k0_b3s5
  s_add_u32 s42, s40, 40960
  buffer_load_dwordx4 v[180:183], v2, s[4:7], s42 offen offset:0 nt
L_k0_b3s5:
  s_memrealtime s[94:95]
  ds_read_b32 v31, v33 offset:6208
  v_dot2_f32_bf16 v42, v168, v4, 0
  v_dot2_f32_bf16 v42, v169, v5, v42
  v_dot2_f32_bf16 v42, v170, v6, v42
  v_dot2_f32_bf16 v42, v171, v7, v42
  s_waitcnt vmcnt(3)
  s_add_u32 s42, s40, 49152
  buffer_load_dwordx4 v[184:187], v2, s[4:7], s42 offen offset:0 nt
  v_dot2_f32_bf16 v43, v172, v4, 0
  v_dot2_f32_bf16 v43, v173, v5, v43
  v_dot2_f32_bf16 v43, v174, v6, v43
  v_dot2_f32_bf16 v43, v175, v7, v43
  s_add_u32 s92, s92, 120
  s_waitcnt lgkmcnt(0)
  v_readfirstlane_b32 s63, v31
  s_sub_u32 s93, s94, s92
  s_sub_u32 s43, s63, s93
  s_cmp_eq_u32 s63, 0x80000000
  s_cselect_b32 s43, 0, s43
  s_cselect_b32 s96, s61, 3
  s_cmp_gt_i32 s43, s13
  s_cselect_b32 s96, 2, s96
  s_cmp_lt_i32 s43, s14
  s_cselect_b32 s96, 4, s96
  s_cmp_lt_i32 s43, s15
  s_cselect_b32 s96, 6, s96
  s_mov_b32 s99, 3
  s_branch L_k1_next
L_k0_b4:
  s_waitcnt vmcnt(3)
  s_cmp_gt_u32 s99, 4
  s_cbranch_scc1 L_k0_b4s4
  s_add_u32 s42, s40, 32768
  buffer_load_dwordx4 v[176:179], v2, s[4:7], s42 offen offset:0 nt
L_k0_b4s4:
  s_lshl_b32 s47, s90, 10
  s_add_u32 s43, s47, s91
  s_mul_i32 s47, s90, s46
  s_bitcmp1_b32 s37, s98
  s_cselect_b32 m0, s43, s36
  s_cselect_b32 s22, s60, 0
  s_cselect_b32 s43, 1, 0
  buffer_load_dwordx4 v39, s[20:23], s47 offen  lds
  s_add_u32 s90, s90, s43
  s_and_b32 s43, s98, 7
  s_cmp_lg_u32 s43, s3
  s_cbranch_scc1 L_c0_5
  v_mov_b32 v32, s93
  s_mov_b32 s62, s93
  s_mul_i32 s47, s98, 8192
  buffer_store_dword v32, v36, s[24:27], s47 offen sc1
  s_lshr_b32 s43, s2, 3
  s_mul_i32 s47, s98, 5
  s_add_u32 s43, s43, s47
  s_and_b32 s43, s43, 3
  s_mul_i32 s43, s43, 2048
  s_add_u32 s43, s43, 1048576
  s_sub_u32 s47, s98, 1
  s_max_i32 s47, s47, 0
  s_mul_i32 s47, s47, 8192
  s_add_u32 s43, s43, s47
  buffer_load_dword v34, v35, s[24:27], s43 offen
L_c0_5:
  v_dot2_f32_bf16 v40, v160, v4, 0
  v_dot2_f32_bf16 v40, v161, v5, v40
  v_dot2_f32_bf16 v40, v162, v6, v40
  v_dot2_f32_bf16 v40, v163, v7, v40
  s_waitcnt vmcnt(4)
  s_cmp_gt_u32 s99, 5
  s_cbranch_scc1 L_k0_b4s5
  s_add_u32 s42, s40, 40960
  buffer_load_dwordx4 v[180:183], v2, s[4:7], s42 offen offset:0 nt
L_k0_b4s5:
  v_dot2_f32_bf16 v41, v164, v4, 0
  v_dot2_f32_bf16 v41, v165, v5, v41
  v_dot2_f32_bf16 v41, v166, v6, v41
  v_dot2_f32_bf16 v41, v167, v7, v41
  s_waitcnt vmcnt(4)
  s_add_u32 s42, s40, 49152
  buffer_load_dwordx4 v[184:187], v2, s[4:7], s42 offen offset:0 nt
  s_memrealtime s[94:95]
  ds_read_b32 v31, v33 offset:6208
  v_dot2_f32_bf16 v42, v168, v4, 0
  v_dot2_f32_bf16 v42, v169, v5, v42
  v_dot2_f32_bf16 v42, v170, v6, v42
  v_dot2_f32_bf16 v42, v171, v7, v42
  s_waitcnt vmcnt(4)
  s_add_u32 s42, s40, 57344
  buffer_load_dwordx4 v[188:191], v2, s[4:7], s42 offen offset:0 nt
  v_dot2_f32_bf16 v43, v172, v4, 0
  v_dot2_f32_bf16 v43, v173, v5, v43
  v_dot2_f32_bf16 v43, v174, v6, v43
  v_dot2_f32_bf16 v43, v175, v7, v43
  s_add_u32 s92, s92, 120
  s_waitcnt lgkmcnt(0)
  v_readfirstlane_b32 s63, v31
  s_sub_u32 s93, s94, s92
  s_sub_u32 s43, s63, s93
  s_cmp_eq_u32 s63, 0x80000000
  s_cselect_b32 s43, 0, s43
  s_cselect_b32 s96, s61, 3
  s_cmp_gt_i32 s43, s13
  s_cselect_b32 s96, 2, s96
  s_cmp_lt_i32 s43, s14
  s_cselect_b32 s96, 4, s96
  s_cmp_lt_i32 s43, s15
  s_cselect_b32 s96, 6, s96
  s_mov_b32 s99, 4
  s_branch L_k1_next
L_k0_b6:
  s_waitcnt vmcnt(5)
  s_add_u32 s42, s40, 49152
  buffer_load_dwordx4 v[184:187], v2, s[4:7], s42 offen offset:0 nt
  s_lshl_b32 s47, s90, 10
  s_add_u32 s43, s47, s91
  s_mul_i32 s47, s90, s46
  s_bitcmp1_b32 s37, s98
  s_cselect_b32 m0, s43, s36
  s_cselect_b32 s22, s60, 0
  s_cselect_b32 s43, 1, 0
  buffer_load_dwordx4 v39, s[20:23], s47 offen  lds
  s_add_u32 s90, s90, s43
  s_and_b32 s43, s98, 7
  s_cmp_lg_u32 s43, s3
  s_cbranch_scc1 L_c0_6
  v_mov_b32 v32, s93
  s_mov_b32 s62, s93
  s_mul_i32 s47, s98, 8192
  buffer_store_dword v32, v36, s[24:27], s47 offen sc1
  s_lshr_b32 s43, s2, 3
  s_mul_i32 s47, s98, 5
  s_add_u32 s43, s43, s47
  s_and_b32 s43, s43, 3
  s_mul_i32 s43, s43, 2048
  s_add_u32 s43, s43, 1048576
  s_sub_u32 s47, s98, 1
  s_max_i32 s47, s47, 0
  s_mul_i32 s47, s47, 8192
  s_add_u32 s43, s43, s47
  buffer_load_dword v34, v35, s[24:27], s43 offen
L_c0_6:
  v_dot2_f32_bf16 v40, v160, v4, 0
  v_dot2_f32_bf16 v40, v161, v5, v40
  v_dot2_f32_bf16 v40, v162, v6, v40
  v_dot2_f32_bf16 v40, v163, v7, v40
  s_waitcnt vmcnt(6)
  s_add_u32 s42, s40, 57344
  buffer_load_dwordx4 v[188:191], v2, s[4:7], s42 offen offset:0 nt
  v_dot2_f32_bf16 v41, v164, v4, 0
  v_dot2_f32_bf16 v41, v165, v5, v41
  v_dot2_f32_bf16 v41, v166, v6, v41
  v_dot2_f32_bf16 v41, v167, v7, v41
  s_waitcnt vmcnt(6)
  s_add_u32 s42, s40, 65536
  buffer_load_dwordx4 v[192:195], v2, s[4:7], s42 offen offset:0 nt
  s_memrealtime s[94:95]
  ds_read_b32 v31, v33 offset:6208
  v_dot2_f32_bf16 v42, v168, v4, 0
  v_dot2_f32_bf16 v42, v169, v5, v42
  v_dot2_f32_bf16 v42, v170, v6, v42
  v_dot2_f32_bf16 v42, v171, v7, v42
  s_waitcnt vmcnt(6)
  s_add_u32 s42, s40, 73728
  buffer_load_dwordx4 v[196:199], v2, s[4:7], s42 offen offset:0 nt
  v_dot2_f32_bf16 v43, v172, v4, 0
  v_dot2_f32_bf16 v43, v173, v5, v43
  v_dot2_f32_bf16 v43, v174, v6, v43
  v_dot2_f32_bf16 v43, v175, v7, v43
  s_add_u32 s92, s92, 120
  s_waitcnt lgkmcnt(0)
  v_readfirstlane_b32 s63, v31
  s_sub_u32 s93, s94, s92
  s_sub_u32 s43, s63, s93
  s_cmp_eq_u32 s63, 0x80000000
  s_cselect_b32 s43, 0, s43
  s_cselect_b32 s96, s61, 3
  s_cmp_gt_i32 s43, s13
  s_cselect_b32 s96, 2, s96
  s_cmp_lt_i32 s43, s14
  s_cselect_b32 s96, 4, s96
  s_cmp_lt_i32 s43, s15
  s_cselect_b32 s96, 6, s96
  s_mov_b32 s99, 6
  s_branch L_k1_next
L_k1_next:
  s_cmp_gt_u32 s99, 2
  s_cbranch_scc1 L_k1_u2
  s_cmp_le_u32 s96, 2
  s_cbranch_scc1 L_k1_u2
  s_add_u32 s42, s40, 49152
  buffer_load_dwordx4 v[184:187], v2, s[4:7], s42 offen offset:0 nt
L_k1_u2:
  s_cmp_gt_u32 s99, 3
  s_cbranch_scc1 L_k1_u3
  s_cmp_le_u32 s96, 3
  s_cbranch_scc1 L_k1_u3
  s_add_u32 s42, s40, 57344
  buffer_load_dwordx4 v[188:191], v2, s[4:7], s42 offen offset:0 nt
L_k1_u3:
  s_cmp_gt_u32 s99, 4
  s_cbranch_scc1 L_k1_u4
  s_cmp_le_u32 s96, 4
  s_cbranch_scc1 L_k1_u4
  s_add_u32 s42, s40, 65536
  buffer_load_dwordx4 v[192:195], v2, s[4:7], s42 offen offset:0 nt
L_k1_u4:
  s_cmp_gt_u32 s99, 5
  s_cbranch_scc1 L_k1_u5
  s_cmp_le_u32 s96, 5
  s_cbranch_scc1 L_k1_u5
  s_add_u32 s42, s40, 73728
  buffer_load_dwordx4 v[196:199], v2, s[4:7], s42 offen offset:0 nt
L_k1_u5:
  s_cmp_eq_u32 s96, 3
  s_cbranch_scc1 L_k1_b3
  s_cmp_eq_u32 s96, 4
  s_cbranch_scc1 L_k1_b4
  s_cmp_eq_u32 s96, 6
  s_cbranch_scc1 L_k1_b6
L_k1_b2:
  s_waitcnt vmcnt(1)
  s_cmp_gt_u32 s99, 2
  s_cbranch_scc1 L_k1_b2s2
  s_add_u32 s42, s40, 49152
  buffer_load_dwordx4 v[184:187], v2, s[4:7], s42 offen offset:0 nt
L_k1_b2s2:
  v_dot2_f32_bf16 v44, v176, v4, 0
  v_dot2_f32_bf16 v44, v177, v5, v44
  v_dot2_f32_bf16 v44, v178, v6, v44
  v_dot2_f32_bf16 v44, v179, v7, v44
  s_waitcnt vmcnt(1)
  s_cmp_gt_u32 s99, 3
  s_cbranch_scc1 L_k1_b2s3
  s_add_u32 s42, s40, 57344
  buffer_load_dwordx4 v[188:191], v2, s[4:7], s42 offen offset:0 nt
L_k1_b2s3:
  v_dot2_f32_bf16 v45, v180, v4, 0
  v_dot2_f32_bf16 v45, v181, v5, v45
  v_dot2_f32_bf16 v45, v182, v6, v45
  v_dot2_f32_bf16 v45, v183, v7, v45
  s_waitcnt vmcnt(1)
  s_cmp_gt_u32 s99, 4
  s_cbranch_scc1 L_k1_b2s4
  s_add_u32 s42, s40, 65536
  buffer_load_dwordx4 v[192:195], v2, s[4:7], s42 offen offset:0 nt
L_k1_b2s4:
  s_memrealtime s[94:95]
  ds_read_b32 v31, v33 offset:6208
  v_dot2_f32_bf16 v46, v184, v4, 0
  v_dot2_f32_bf16 v46, v185, v5, v46
  v_dot2_f32_bf16 v46, v186, v6, v46
  v_dot2_f32_bf16 v46, v187, v7, v46
  s_waitcnt vmcnt(1)
  s_cmp_gt_u32 s99, 5
  s_cbranch_scc1 L_k1_b2s5
  s_add_u32 s42, s40, 73728
  buffer_load_dwordx4 v[196:199], v2, s[4:7], s42 offen offset:0 nt
L_k1_b2s5:
  v_dot2_f32_bf16 v47, v188, v4, 0
  v_dot2_f32_bf16 v47, v189, v5, v47
  v_dot2_f32_bf16 v47, v190, v6, v47
  v_dot2_f32_bf16 v47, v191, v7, v47
  s_add_u32 s92, s92, 120
  s_waitcnt lgkmcnt(0)
  v_readfirstlane_b32 s63, v31
  s_sub_u32 s93, s94, s92
  s_sub_u32 s43, s63, s93
  s_cmp_eq_u32 s63, 0x80000000
  s_cselect_b32 s43, 0, s43
  s_cselect_b32 s96, s61, 3
  s_cmp_gt_i32 s43, s13
  s_cselect_b32 s96, 2, s96
  s_cmp_lt_i32 s43, s14
  s_cselect_b32 s96, 4, s96
  s_cmp_lt_i32 s43, s15
  s_cselect_b32 s96, 6, s96
  s_mov_b32 s99, 2
  s_branch L_k2_next
L_k1_b3:
  s_waitcnt vmcnt(2)
  s_cmp_gt_u32 s99, 3
  s_cbranch_scc1 L_k1_b3s3
  s_add_u32 s42, s40, 57344
  buffer_load_dwordx4 v[188:191], v2, s[4:7], s42 offen offset:0 nt
L_k1_b3s3:
  v_dot2_f32_bf16 v44, v176, v4, 0
  v_dot2_f32_bf16 v44, v177, v5, v44
  v_dot2_f32_bf16 v44, v178, v6, v44
  v_dot2_f32_bf16 v44, v179, v7, v44
  s_waitcnt vmcnt(2)
  s_cmp_gt_u32 s99, 4
  s_cbranch_scc1 L_k1_b3s4
  s_add_u32 s42, s40, 65536
  buffer_load_dwordx4 v[192:195], v2, s[4:7], s42 offen offset:0 nt
L_k1_b3s4:
  v_dot2_f32_bf16 v45, v180, v4, 0
  v_dot2_f32_bf16 v45, v181, v5, v45
  v_dot2_f32_bf16 v45, v182, v6, v45
  v_dot2_f32_bf16 v45, v183, v7, v45
  s_waitcnt vmcnt(2)
  s_cmp_gt_u32 s99, 5
  s_cbranch_scc1 L_k1_b3s5
  s_add_u32 s42, s40, 73728
  buffer_load_dwordx4 v[196:199], v2, s[4:7], s42 offen offset:0 nt
L_k1_b3s5:
  s_memrealtime s[94:95]
  ds_read_b32 v31, v33 offset:6208
  v_dot2_f32_bf16 v46, v184, v4, 0
  v_dot2_f32_bf16 v46, v185, v5, v46
  v_dot2_f32_bf16 v46, v186, v6, v46
  v_dot2_f32_bf16 v46, v187, v7, v46
  s_waitcnt vmcnt(2)
  s_add_u32 s42, s40, 81920
  buffer_load_dwordx4 v[200:203], v2, s[4:7], s42 offen offset:0 nt
  v_dot2_f32_bf16 v47, v188, v4, 0
  v_dot2_f32_bf16 v47, v189, v5, v47
  v_dot2_f32_bf16 v47, v190, v6, v47
  v_dot2_f32_bf16 v47, v191, v7, v47
  s_add_u32 s92, s92, 120
  s_waitcnt lgkmcnt(0)
  v_readfirstlane_b32 s63, v31
  s_sub_u32 s93, s94, s92
  s_sub_u32 s43, s63, s93
  s_cmp_eq_u32 s63, 0x80000000
  s_cselect_b32 s43, 0, s43
  s_cselect_b32 s96, s61, 3
  s_cmp_gt_i32 s43, s13
  s_cselect_b32 s96, 2, s96
  s_cmp_lt_i32 s43, s14
  s_cselect_b32 s96, 4, s96
  s_cmp_lt_i32 s43, s15
  s_cselect_b32 s96, 6, s96
  s_mov_b32 s99, 3
  s_branch L_k2_next
L_k1_b4:
  s_waitcnt vmcnt(3)
  s_cmp_gt_u32 s99, 4
  s_cbranch_scc1 L_k1_b4s4
  s_add_u32 s42, s40, 65536
  buffer_load_dwordx4 v[192:195], v2, s[4:7], s42 offen offset:0 nt
L_k1_b4s4:
  v_dot2_f32_bf16 v44, v176, v4, 0
  v_dot2_f32_bf16 v44, v177, v5, v44
  v_dot2_f32_bf16 v44, v178, v6, v44
  v_dot2_f32_bf16 v44, v179, v7, v44
  s_waitcnt vmcnt(3)
  s_cmp_gt_u32 s99, 5
  s_cbranch_scc1 L_k1_b4s5
  s_add_u32 s42, s40, 73728
  buffer_load_dwordx4 v[196:199], v2, s[4:7], s42 offen offset:0 nt
L_k1_b4s5:
  v_dot2_f32_bf16 v45, v180, v4, 0
  v_dot2_f32_bf16 v45, v181, v5, v45
  v_dot2_f32_bf16 v45, v182, v6, v45
  v_dot2_f32_bf16 v45, v183, v7, v45
  s_waitcnt vmcnt(3)
  s_add_u32 s42, s40, 81920
  buffer_load_dwordx4 v[200:203], v2, s[4:7], s42 offen offset:0 nt
  s_memrealtime s[94:95]
  ds_read_b32 v31, v33 offset:6208
  v_dot2_f32_bf16 v46, v184, v4, 0
  v_dot2_f32_bf16 v46, v185, v5, v46
  v_dot2_f32_bf16 v46, v186, v6, v46
  v_dot2_f32_bf16 v46, v187, v7, v46
  s_waitcnt vmcnt(3)
  s_add_u32 s42, s40, 90112
  buffer_load_dwordx4 v[204:207], v2, s[4:7], s42 offen offset:0 nt
  v_dot2_f32_bf16 v47, v188, v4, 0
  v_dot2_f32_bf16 v47, v189, v5, v47
  v_dot2_f32_bf16 v47, v190, v6, v47
  v_dot2_f32_bf16 v47, v191, v7, v47
  s_add_u32 s92, s92, 120
  s_waitcnt lgkmcnt(0)
  v_readfirstlane_b32 s63, v31
  s_sub_u32 s93, s94, s92
  s_sub_u32 s43, s63, s93
  s_cmp_eq_u32 s63, 0x80000000
  s_cselect_b32 s43, 0, s43
  s_cselect_b32 s96, s61, 3
  s_cmp_gt_i32 s43, s13
  s_cselect_b32 s96, 2, s96
  s_cmp_lt_i32 s43, s14
  s_cselect_b32 s96, 4, s96
  s_cmp_lt_i32 s43, s15
  s_cselect_b32 s96, 6, s96
  s_mov_b32 s99, 4
  s_branch L_k2_next
L_k1_b6:
  s_waitcnt vmcnt(5)
  s_add_u32 s42, s40, 81920
  buffer_load_dwordx4 v[200:203], v2, s[4:7], s42 offen offset:0 nt
  v_dot2_f32_bf16 v44, v176, v4, 0
  v_dot2_f32_bf16 v44, v177, v5, v44
  v_dot2_f32_bf16 v44, v178, v6, v44
  v_dot2_f32_bf16 v44, v179, v7, v44
  s_waitcnt vmcnt(5)
  s_add_u32 s42, s40, 90112
  buffer_load_dwordx4 v[204:207], v2, s[4:7], s42 offen offset:0 nt
  v_dot2_f32_bf16 v45, v180, v4, 0
  v_dot2_f32_bf16 v45, v181, v5, v45
  v_dot2_f32_bf16 v45, v182, v6, v45
  v_dot2_f32_bf16 v45, v183, v7, v45
  s_waitcnt vmcnt(5)
  s_add_u32 s42, s40, 98304
  buffer_load_dwordx4 v[208:211], v2, s[4:7], s42 offen offset:0 nt
  s_memrealtime s[94:95]
  ds_read_b32 v31, v33 offset:6208
  v_dot2_f32_bf16 v46, v184, v4, 0
  v_dot2_f32_bf16 v46, v185, v5, v46
  v_dot2_f32_bf16 v46, v186, v6, v46
  v_dot2_f32_bf16 v46, v187, v7, v46
  s_waitcnt vmcnt(5)
  s_add_u32 s42, s40, 106496
  buffer_load_dwordx4 v[212:215], v2, s[4:7], s42 offen offset:0 nt
  v_dot2_f32_bf16 v47, v188, v4, 0
  v_dot2_f32_bf16 v47, v189, v5, v47
  v_dot2_f32_bf16 v47, v190, v6, v47
  v_dot2_f32_bf16 v47, v191, v7, v47
  s_add_u32 s92, s92, 120
  s_waitcnt lgkmcnt(0)
  v_readfirstlane_b32 s63, v31
  s_sub_u32 s93, s94, s92
  s_sub_u32 s43, s63, s93
  s_cmp_eq_u32 s63, 0x80000000
  s_cselect_b32 s43, 0, s43
  s_cselect_b32 s96, s61, 3
  s_cmp_gt_i32 s43, s13
  s_cselect_b32 s96, 2, s96
  s_cmp_lt_i32 s43, s14
  s_cselect_b32 s96, 4, s96
  s_cmp_lt_i32 s43, s15
  s_cselect_b32 s96, 6, s96
  s_mov_b32 s99, 6
  s_branch L_k2_next
L_k2_next:
  s_cmp_gt_u32 s99, 2
  s_cbranch_scc1 L_k2_u2
  s_cmp_le_u32 s96, 2
  s_cbranch_scc1 L_k2_u2
  s_add_u32 s42, s40, 81920
  buffer_load_dwordx4 v[200:203], v2, s[4:7], s42 offen offset:0 nt
L_k2_u2:
  s_cmp_gt_u32 s99, 3
  s_cbranch_scc1 L_k2_u3
  s_cmp_le_u32 s96, 3
  s_cbranch_scc1 L_k2_u3
  s_add_u32 s42, s40, 90112
  buffer_load_dwordx4 v[204:207], v2, s[4:7], s42 offen offset:0 nt
L_k2_u3:
  s_cmp_gt_u32 s99, 4
  s_cbranch_scc1 L_k2_u4
  s_cmp_le_u32 s96, 4
  s_cbranch_scc1 L_k2_u4
  s_add_u32 s42, s40, 98304
  buffer_load_dwordx4 v[208:211], v2, s[4:7], s42 offen offset:0 nt
L_k2_u4:
  s_cmp_gt_u32 s99, 5
  s_cbranch_scc1 L_k2_u5
  s_cmp_le_u32 s96, 5
  s_cbranch_scc1 L_k2_u5
  s_add_u32 s42, s40, 106496
  buffer_load_dwordx4 v[212:215], v2, s[4:7], s42 offen offset:0 nt
L_k2_u5:
  s_cmp_eq_u32 s96, 3
  s_cbranch_scc1 L_k2_b3
  s_cmp_eq_u32 s96, 4
  s_cbranch_scc1 L_k2_b4
  s_cmp_eq_u32 s96, 6
  s_cbranch_scc1 L_k2_b6
L_k2_b2:
  s_waitcnt vmcnt(1)
  s_cmp_gt_u32 s99, 2
  s_cbranch_scc1 L_k2_b2s2
  s_add_u32 s42, s40, 81920
  buffer_load_dwordx4 v[200:203], v2, s[4:7], s42 offen offset:0 nt
L_k2_b2s2:
  v_dot2_f32_bf16 v48, v192, v4, 0
  v_dot2_f32_bf16 v48, v193, v5, v48
  v_dot2_f32_bf16 v48, v194, v6, v48
  v_dot2_f32_bf16 v48, v195, v7, v48
  s_waitcnt vmcnt(1)
  s_cmp_gt_u32 s99, 3
  s_cbranch_scc1 L_k2_b2s3
  s_add_u32 s42, s40, 90112
  buffer_load_dwordx4 v[204:207], v2, s[4:7], s42 offen offset:0 nt
L_k2_b2s3:
  v_dot2_f32_bf16 v49, v196, v4, 0
  v_dot2_f32_bf16 v49, v197, v5, v49
  v_dot2_f32_bf16 v49, v198, v6, v49
  v_dot2_f32_bf16 v49, v199, v7, v49
  s_waitcnt vmcnt(1)
  s_cmp_gt_u32 s99, 4
  s_cbranch_scc1 L_k2_b2s4
  s_add_u32 s42, s40, 98304
  buffer_load_dwordx4 v[208:211], v2, s[4:7], s42 offen offset:0 nt
L_k2_b2s4:
  s_memrealtime s[94:95]
  ds_read_b32 v31, v33 offset:6208
  v_dot2_f32_bf16 v50, v200, v4, 0
  v_dot2_f32_bf16 v50, v201, v5, v50
  v_dot2_f32_bf16 v50, v202, v6, v50
  v_dot2_f32_bf16 v50, v203, v7, v50
  s_waitcnt vmcnt(1)
  s_cmp_gt_u32 s99, 5
  s_cbranch_scc1 L_k2_b2s5
  s_add_u32 s42, s40, 106496
  buffer_load_dwordx4 v[212:215], v2, s[4:7], s42 offen offset:0 nt
L_k2_b2s5:
  v_dot2_f32_bf16 v51, v204, v4, 0
  v_dot2_f32_bf16 v51, v205, v5, v51
  v_dot2_f32_bf16 v51, v206, v6, v51
  v_dot2_f32_bf16 v51, v207, v7, v51
  s_add_u32 s92, s92, 120
  s_waitcnt lgkmcnt(0)
  v_readfirstlane_b32 s63, v31
  s_sub_u32 s93, s94, s92
  s_sub_u32 s43, s63, s93
  s_cmp_eq_u32 s63, 0x80000000
  s_cselect_b32 s43, 0, s43
  s_cselect_b32 s96, s61, 3
  s_cmp_gt_i32 s43, s13
  s_cselect_b32 s96, 2, s96
  s_cmp_lt_i32 s43, s14
  s_cselect_b32 s96, 4, s96
  s_cmp_lt_i32 s43, s15
  s_cselect_b32 s96, 6, s96
  s_mov_b32 s99, 2
  s_branch L_k3_next
L_k2_b3:
  s_waitcnt vmcnt(2)
  s_cmp_gt_u32 s99, 3
  s_cbranch_scc1 L_k2_b3s3
  s_add_u32 s42, s40, 90112
  buffer_load_dwordx4 v[204:207], v2, s[4:7], s42 offen offset:0 nt
L_k2_b3s3:
  v_dot2_f32_bf16 v48, v192, v4, 0
  v_dot2_f32_bf16 v48, v193, v5, v48
  v_dot2_f32_bf16 v48, v194, v6, v48
  v_dot2_f32_bf16 v48, v195, v7, v48
  s_waitcnt vmcnt(2)
  s_cmp_gt_u32 s99, 4
  s_cbranch_scc1 L_k2_b3s4
  s_add_u32 s42, s40, 98304
  buffer_load_dwordx4 v[208:211], v2, s[4:7], s42 offen offset:0 nt
L_k2_b3s4:
  v_dot2_f32_bf16 v49, v196, v4, 0
  v_dot2_f32_bf16 v49, v197, v5, v49
  v_dot2_f32_bf16 v49, v198, v6, v49
  v_dot2_f32_bf16 v49, v199, v7, v49
  s_waitcnt vmcnt(2)
  s_cmp_gt_u32 s99, 5
  s_cbranch_scc1 L_k2_b3s5
  s_add_u32 s42, s40, 106496
  buffer_load_dwordx4 v[212:215], v2, s[4:7], s42 offen offset:0 nt
L_k2_b3s5:
  s_memrealtime s[94:95]
  ds_read_b32 v31, v33 offset:6208
  v_dot2_f32_bf16 v50, v200, v4, 0
  v_dot2_f32_bf16 v50, v201, v5, v50
  v_dot2_f32_bf16 v50, v202, v6, v50
  v_dot2_f32_bf16 v50, v203, v7, v50
  s_waitcnt vmcnt(2)
  s_add_u32 s42, s40, 114688
  buffer_load_dwordx4 v[216:219], v2, s[4:7], s42 offen offset:0 nt
  v_dot2_f32_bf16 v51, v204, v4, 0
  v_dot2_f32_bf16 v51, v205, v5, v51
  v_dot2_f32_bf16 v51, v206, v6, v51
  v_dot2_f32_bf16 v51, v207, v7, v51
  s_add_u32 s92, s92, 120
  s_waitcnt lgkmcnt(0)
  v_readfirstlane_b32 s63, v31
  s_sub_u32 s93, s94, s92
  s_sub_u32 s43, s63, s93
  s_cmp_eq_u32 s63, 0x80000000
  s_cselect_b32 s43, 0, s43
  s_cselect_b32 s96, s61, 3
  s_cmp_gt_i32 s43, s13
  s_cselect_b32 s96, 2, s96
  s_cmp_lt_i32 s43, s14
  s_cselect_b32 s96, 4, s96
  s_cmp_lt_i32 s43, s15
  s_cselect_b32 s96, 6, s96
  s_mov_b32 s99, 3
  s_branch L_k3_next
L_k2_b4:
  s_waitcnt vmcnt(3)
  s_cmp_gt_u32 s99, 4
  s_cbranch_scc1 L_k2_b4s4
  s_add_u32 s42, s40, 98304
  buffer_load_dwordx4 v[208:211], v2, s[4:7], s42 offen offset:0 nt
L_k2_b4s4:
  v_dot2_f32_bf16 v48, v192, v4, 0
  v_dot2_f32_bf16 v48, v193, v5, v48
  v_dot2_f32_bf16 v48, v194, v6, v48
  v_dot2_f32_bf16 v48, v195, v7, v48
  s_waitcnt vmcnt(3)
  s_cmp_gt_u32 s99, 5
  s_cbranch_scc1 L_k2_b4s5
  s_add_u32 s42, s40, 106496
  buffer_load_dwordx4 v[212:215], v2, s[4:7], s42 offen offset:0 nt
L_k2_b4s5:
  v_dot2_f32_bf16 v49, v196, v4, 0
  v_dot2_f32_bf16 v49, v197, v5, v49
  v_dot2_f32_bf16 v49, v198, v6, v49
  v_dot2_f32_bf16 v49, v199, v7, v49
  s_waitcnt vmcnt(3)
  s_add_u32 s42, s40, 114688
  buffer_load_dwordx4 v[216:219], v2, s[4:7], s42 offen offset:0 nt
  s_memrealtime s[94:95]
  ds_read_b32 v31, v33 offset:6208
  v_dot2_f32_bf16 v50, v200, v4, 0
  v_dot2_f32_bf16 v50, v201, v5, v50
  v_dot2_f32_bf16 v50, v202, v6, v50
  v_dot2_f32_bf16 v50, v203, v7, v50
  s_waitcnt vmcnt(3)
  s_add_u32 s42, s40, 122880
  buffer_load_dwordx4 v[220:223], v2, s[4:7], s42 offen offset:0 nt
  v_dot2_f32_bf16 v51, v204, v4, 0
  v_dot2_f32_bf16 v51, v205, v5, v51
  v_dot2_f32_bf16 v51, v206, v6, v51
  v_dot2_f32_bf16 v51, v207, v7, v51
  s_add_u32 s92, s92, 120
  s_waitcnt lgkmcnt(0)
  v_readfirstlane_b32 s63, v31
  s_sub_u32 s93, s94, s92
  s_sub_u32 s43, s63, s93
  s_cmp_eq_u32 s63, 0x80000000
  s_cselect_b32 s43, 0, s43
  s_cselect_b32 s96, s61, 3
  s_cmp_gt_i32 s43, s13
  s_cselect_b32 s96, 2, s96
  s_cmp_lt_i32 s43, s14
  s_cselect_b32 s96, 4, s96
  s_cmp_lt_i32 s43, s15
  s_cselect_b32 s96, 6, s96
  s_mov_b32 s99, 4
  s_branch L_k3_next
L_k2_b6:
  s_waitcnt vmcnt(5)
  s_add_u32 s42, s40, 114688
  buffer_load_dwordx4 v[216:219], v2, s[4:7], s42 offen offset:0 nt
  v_dot2_f32_bf16 v48, v192, v4, 0
  v_dot2_f32_bf16 v48, v193, v5, v48
  v_dot2_f32_bf16 v48, v194, v6, v48
  v_dot2_f32_bf16 v48, v195, v7, v48
  s_waitcnt vmcnt(5)
  s_add_u32 s42, s40, 122880
  buffer_load_dwordx4 v[220:223], v2, s[4:7], s42 offen offset:0 nt
  v_dot2_f32_bf16 v49, v196, v4, 0
  v_dot2_f32_bf16 v49, v197, v5, v49
  v_dot2_f32_bf16 v49, v198, v6, v49
  v_dot2_f32_bf16 v49, v199, v7, v49
  s_waitcnt vmcnt(5)
  buffer_load_dwordx4 v[160:163], v2, s[16:19], s97 offen offset:0 nt
  s_memrealtime s[94:95]
  ds_read_b32 v31, v33 offset:6208
  v_dot2_f32_bf16 v50, v200, v4, 0
  v_dot2_f32_bf16 v50, v201, v5, v50
  v_dot2_f32_bf16 v50, v202, v6, v50
  v_dot2_f32_bf16 v50, v203, v7, v50
  s_waitcnt vmcnt(5)
  s_add_u32 s42, s97, 8192
  buffer_load_dwordx4 v[164:167], v2, s[16:19], s42 offen offset:0 nt
  v_dot2_f32_bf16 v51, v204, v4, 0
  v_dot2_f32_bf16 v51, v205, v5, v51
  v_dot2_f32_bf16 v51, v206, v6, v51
  v_dot2_f32_bf16 v51, v207, v7, v51
  s_add_u32 s92, s92, 120
  s_waitcnt lgkmcnt(0)
  v_readfirstlane_b32 s63, v31
  s_sub_u32 s93, s94, s92
  s_sub_u32 s43, s63, s93
  s_cmp_eq_u32 s63, 0x80000000
  s_cselect_b32 s43, 0, s43
  s_cselect_b32 s96, s61, 3
  s_cmp_gt_i32 s43, s13
  s_cselect_b32 s96, 2, s96
  s_cmp_lt_i32 s43, s14
  s_cselect_b32 s96, 4, s96
  s_cmp_lt_i32 s43, s15
  s_cselect_b32 s96, 6, s96
  s_mov_b32 s99, 6
  s_branch L_k3_next
L_k3_next:
  s_cmp_gt_u32 s99, 2
  s_cbranch_scc1 L_k3_u2
  s_cmp_le_u32 s96, 2
  s_cbranch_scc1 L_k3_u2
  s_add_u32 s42, s40, 114688
  buffer_load_dwordx4 v[216:219], v2, s[4:7], s42 offen offset:0 nt
L_k3_u2:
  s_cmp_gt_u32 s99, 3
  s_cbranch_scc1 L_k3_u3
  s_cmp_le_u32 s96, 3
  s_cbranch_scc1 L_k3_u3
  s_add_u32 s42, s40, 122880
  buffer_load_dwordx4 v[220:223], v2, s[4:7], s42 offen offset:0 nt
L_k3_u3:
  s_cmp_gt_u32 s99, 4
  s_cbranch_scc1 L_k3_u4
  s_cmp_le_u32 s96, 4
  s_cbranch_scc1 L_k3_u4
  buffer_load_dwordx4 v[160:163], v2, s[16:19], s97 offen offset:0 nt
L_k3_u4:
  s_cmp_gt_u32 s99, 5
  s_cbranch_scc1 L_k3_u5
  s_cmp_le_u32 s96, 5
  s_cbranch_scc1 L_k3_u5
  s_add_u32 s42, s97, 8192
  buffer_load_dwordx4 v[164:167], v2, s[16:19], s42 offen offset:0 nt
L_k3_u5:
  s_cmp_eq_u32 s96, 3
  s_cbranch_scc1 L_k3_b3
  s_cmp_eq_u32 s96, 4
  s_cbranch_scc1 L_k3_b4
  s_cmp_eq_u32 s96, 6
  s_cbranch_scc1 L_k3_b6
L_k3_b2:
  s_waitcnt vmcnt(1)
  s_cmp_gt_u32 s99, 2
  s_cbranch_scc1 L_k3_b2s2
  s_add_u32 s42, s40, 114688
  buffer_load_dwordx4 v[216:219], v2, s[4:7], s42 offen offset:0 nt
L_k3_b2s2:
  s_and_b32 s43, s98, 7
  s_cmp_lg_u32 s43, s3
  s_cbranch_scc1 L_c1_7
  v_subrev_u32 v34, s62, v34
  v_add_u32 v32, 0x1000, v34
  v_cmp_gt_u32 vcc, 0x2000, v32
  s_nop 1
  v_cndmask_b32 v34, 0, v34, vcc
  s_nop 1
  v_add_u32_dpp v34, v34, v34 row_ror:8 row_mask:0xf bank_mask:0xf
  s_nop 1
  v_add_u32_dpp v34, v34, v34 row_ror:4 row_mask:0xf bank_mask:0xf
  s_nop 1
  v_add_u32_dpp v34, v34, v34 row_ror:2 row_mask:0xf bank_mask:0xf
  s_nop 1
  v_add_u32_dpp v34, v34, v34 row_ror:1 row_mask:0xf bank_mask:0xf
  s_nop 0
  v_readlane_b32 s43, v34, 0
  s_nop 0
  s_ashr_i32 s43, s43, 3
  s_add_u32 s43, s43, s62
  v_mov_b32 v32, s43
  ds_write_b32 v33, v32 offset:6208
L_c1_7:
  v_dot2_f32_bf16 v52, v208, v4, 0
  v_dot2_f32_bf16 v52, v209, v5, v52
  v_dot2_f32_bf16 v52, v210, v6, v52
  v_dot2_f32_bf16 v52, v211, v7, v52
  s_waitcnt vmcnt(1)
  s_cmp_gt_u32 s99, 3
  s_cbranch_scc1 L_k3_b2s3
  s_add_u32 s42, s40, 122880
  buffer_load_dwordx4 v[220:223], v2, s[4:7], s42 offen offset:0 nt
L_k3_b2s3:
  v_dot2_f32_bf16 v53, v212, v4, 0
  v_dot2_f32_bf16 v53, v213, v5, v53
  v_dot2_f32_bf16 v53, v214, v6, v53
  v_dot2_f32_bf16 v53, v215, v7, v53
  s_waitcnt vmcnt(1)
  s_cmp_gt_u32 s99, 4
  s_cbranch_scc1 L_k3_b2s4
  buffer_load_dwordx4 v[160:163], v2, s[16:19], s97 offen offset:0 nt
L_k3_b2s4:
  s_memrealtime s[94:95]
  ds_read_b32 v31, v33 offset:6208
  v_dot2_f32_bf16 v54, v216, v4, 0
  v_dot2_f32_bf16 v54, v217, v5, v54
  v_dot2_f32_bf16 v54, v218, v6, v54
  v_dot2_f32_bf16 v54, v219, v7, v54
  s_waitcnt vmcnt(1)
  s_cmp_gt_u32 s99, 5
  s_cbranch_scc1 L_k3_b2s5
  s_add_u32 s42, s97, 8192
  buffer_load_dwordx4 v[164:167], v2, s[16:19], s42 offen offset:0 nt
L_k3_b2s5:
  v_dot2_f32_bf16 v55, v220, v4, 0
  v_dot2_f32_bf16 v55, v221, v5, v55
  v_dot2_f32_bf16 v55, v222, v6, v55
  v_dot2_f32_bf16 v55, v223, v7, v55
  v_add_f32_dpp v40, v40, v40 row_shl:8 row_mask:0xf bank_mask:0x3
  v_add_f32_dpp v41, v41, v41 row_shl:8 row_mask:0xf bank_mask:0x3
  v_add_f32_dpp v42, v42, v42 row_shl:8 row_mask:0xf bank_mask:0x3
  v_add_f32_dpp v43, v43, v43 row_shl:8 row_mask:0xf bank_mask:0x3
  v_add_f32_dpp v44, v44, v44 row_shl:8 row_mask:0xf bank_mask:0x3
  v_add_f32_dpp v45, v45, v45 row_shl:8 row_mask:0xf bank_mask:0x3
  v_add_f32_dpp v46, v46, v46 row_shl:8 row_mask:0xf bank_mask:0x3
  v_add_f32_dpp v47, v47, v47 row_shl:8 row_mask:0xf bank_mask:0x3
  v_add_f32_dpp v40, v48, v48 row_shr:8 row_mask:0xf bank_mask:0xc
  v_add_f32_dpp v41, v49, v49 row_shr:8 row_mask:0xf bank_mask:0xc
  v_add_f32_dpp v42, v50, v50 row_shr:8 row_mask:0xf bank_mask:0xc
  v_add_f32_dpp v43, v51, v51 row_shr:8 row_mask:0xf bank_mask:0xc
  v_add_f32_dpp v44, v52, v52 row_shr:8 row_mask:0xf bank_mask:0xc
  v_add_f32_dpp v45, v53, v53 row_shr:8 row_mask:0xf bank_mask:0xc
  v_add_f32_dpp v46, v54, v54 row_shr:8 row_mask:0xf bank_mask:0xc
  v_add_f32_dpp v47, v55, v55 row_shr:8 row_mask:0xf bank_mask:0xc
  v_add_f32_dpp v40, v40, v40 row_shl:4 row_mask:0xf bank_mask:0x5
  v_add_f32_dpp v41, v41, v41 row_shl:4 row_mask:0xf bank_mask:0x5
  v_add_f32_dpp v42, v42, v42 row_shl:4 row_mask:0xf bank_mask:0x5
  v_add_f32_dpp v43, v43, v43 row_shl:4 row_mask:0xf bank_mask:0x5
  v_add_f32_dpp v40, v44, v44 row_shr:4 row_mask:0xf bank_mask:0xa
  v_add_f32_dpp v41, v45, v45 row_shr:4 row_mask:0xf bank_mask:0xa
  v_add_f32_dpp v42, v46, v46 row_shr:4 row_mask:0xf bank_mask:0xa
  v_add_f32_dpp v43, v47, v47 row_shr:4 row_mask:0xf bank_mask:0xa
  v_add_f32_dpp v40, v40, v40 quad_perm:[2,3,0,1] row_mask:0xf bank_mask:0xf
  v_add_f32_dpp v41, v41, v41 quad_perm:[2,3,0,1] row_mask:0xf bank_mask:0xf
  v_add_f32_dpp v42, v42, v42 quad_perm:[2,3,0,1] row_mask:0xf bank_mask:0xf
  v_add_f32_dpp v43, v43, v43 quad_perm:[2,3,0,1] row_mask:0xf bank_mask:0xf
  v_cndmask_b32 v40, v40, v42, s[50:51]
  v_cndmask_b32 v41, v41, v43, s[50:51]
  s_nop 0
  v_add_f32_dpp v40, v40, v40 quad_perm:[1,0,3,2] row_mask:0xf bank_mask:0xf
  v_add_f32_dpp v41, v41, v41 quad_perm:[1,0,3,2] row_mask:0xf bank_mask:0xf
  v_mov_b32 v56, v57
  v_mov_b32 v57, v58
  v_mov_b32 v58, v59
  v_mov_b32 v59, v60
  v_mov_b32 v60, v61
  v_mov_b32 v61, v62
  v_mov_b32 v62, v63
  v_cndmask_b32 v40, v40, v41, s[52:53]
  v_cvt_pk_bf16_f32 v40, 0, v40
  v_mul_f32 v40, s54, v40
  v_cvt_pk_bf16_f32 v63, 0, v40
  s_add_u32 s92, s92, 120
  s_waitcnt lgkmcnt(0)
  v_readfirstlane_b32 s63, v31
  s_sub_u32 s93, s94, s92
  s_sub_u32 s43, s63, s93
  s_cmp_eq_u32 s63, 0x80000000
  s_cselect_b32 s43, 0, s43
  s_cselect_b32 s96, s61, 3
  s_cmp_gt_i32 s43, s13
  s_cselect_b32 s96, 2, s96
  s_cmp_lt_i32 s43, s14
  s_cselect_b32 s96, 4, s96
  s_cmp_lt_i32 s43, s15
  s_cselect_b32 s96, 6, s96
  s_mov_b32 s99, 2
  s_branch L_k0_next
L_k3_b3:
  s_waitcnt vmcnt(2)
  s_cmp_gt_u32 s99, 3
  s_cbranch_scc1 L_k3_b3s3
  s_add_u32 s42, s40, 122880
  buffer_load_dwordx4 v[220:223], v2, s[4:7], s42 offen offset:0 nt
L_k3_b3s3:
  s_and_b32 s43, s98, 7
  s_cmp_lg_u32 s43, s3
  s_cbranch_scc1 L_c1_8
  v_subrev_u32 v34, s62, v34
  v_add_u32 v32, 0x1000, v34
  v_cmp_gt_u32 vcc, 0x2000, v32
  s_nop 1
  v_cndmask_b32 v34, 0, v34, vcc
  s_nop 1
  v_add_u32_dpp v34, v34, v34 row_ror:8 row_mask:0xf bank_mask:0xf
  s_nop 1
  v_add_u32_dpp v34, v34, v34 row_ror:4 row_mask:0xf bank_mask:0xf
  s_nop 1
  v_add_u32_dpp v34, v34, v34 row_ror:2 row_mask:0xf bank_mask:0xf
  s_nop 1
  v_add_u32_dpp v34, v34, v34 row_ror:1 row_mask:0xf bank_mask:0xf
  s_nop 0
  v_readlane_b32 s43, v34, 0
  s_nop 0
  s_ashr_i32 s43, s43, 3
  s_add_u32 s43, s43, s62
  v_mov_b32 v32, s43
  ds_write_b32 v33, v32 offset:6208
L_c1_8:
  v_dot2_f32_bf16 v52, v208, v4, 0
  v_dot2_f32_bf16 v52, v209, v5, v52
  v_dot2_f32_bf16 v52, v210, v6, v52
  v_dot2_f32_bf16 v52, v211, v7, v52
  s_waitcnt vmcnt(2)
  s_cmp_gt_u32 s99, 4
  s_cbranch_scc1 L_k3_b3s4
  buffer_load_dwordx4 v[160:163], v2, s[16:19], s97 offen offset:0 nt
L_k3_b3s4:
  v_dot2_f32_bf16 v53, v212, v4, 0
  v_dot2_f32_bf16 v53, v213, v5, v53
  v_dot2_f32_bf16 v53, v214, v6, v53
  v_dot2_f32_bf16 v53, v215, v7, v53
  s_waitcnt vmcnt(2)
  s_cmp_gt_u32 s99, 5
  s_cbranch_scc1 L_k3_b3s5
  s_add_u32 s42, s97, 8192
  buffer_load_dwordx4 v[164:167], v2, s[16:19], s42 offen offset:0 nt
L_k3_b3s5:
  s_memrealtime s[94:95]
  ds_read_b32 v31, v33 offset:6208
  v_dot2_f32_bf16 v54, v216, v4, 0
  v_dot2_f32_bf16 v54, v217, v5, v54
  v_dot2_f32_bf16 v54, v218, v6, v54
  v_dot2_f32_bf16 v54, v219, v7, v54
  s_waitcnt vmcnt(2)
  s_add_u32 s42, s97, 16384
  buffer_load_dwordx4 v[168:171], v2, s[16:19], s42 offen offset:0 nt
  v_dot2_f32_bf16 v55, v220, v4, 0
  v_dot2_f32_bf16 v55, v221, v5, v55
  v_dot2_f32_bf16 v55, v222, v6, v55
  v_dot2_f32_bf16 v55, v223, v7, v55
  v_add_f32_dpp v40, v40, v40 row_shl:8 row_mask:0xf bank_mask:0x3
  v_add_f32_dpp v41, v41, v41 row_shl:8 row_mask:0xf bank_mask:0x3
  v_add_f32_dpp v42, v42, v42 row_shl:8 row_mask:0xf bank_mask:0x3
  v_add_f32_dpp v43, v43, v43 row_shl:8 row_mask:0xf bank_mask:0x3
  v_add_f32_dpp v44, v44, v44 row_shl:8 row_mask:0xf bank_mask:0x3
  v_add_f32_dpp v45, v45, v45 row_shl:8 row_mask:0xf bank_mask:0x3
  v_add_f32_dpp v46, v46, v46 row_shl:8 row_mask:0xf bank_mask:0x3
  v_add_f32_dpp v47, v47, v47 row_shl:8 row_mask:0xf bank_mask:0x3
  v_add_f32_dpp v40, v48, v48 row_shr:8 row_mask:0xf bank_mask:0xc
  v_add_f32_dpp v41, v49, v49 row_shr:8 row_mask:0xf bank_mask:0xc
  v_add_f32_dpp v42, v50, v50 row_shr:8 row_mask:0xf bank_mask:0xc
  v_add_f32_dpp v43, v51, v51 row_shr:8 row_mask:0xf bank_mask:0xc
  v_add_f32_dpp v44, v52, v52 row_shr:8 row_mask:0xf bank_mask:0xc
  v_add_f32_dpp v45, v53, v53 row_shr:8 row_mask:0xf bank_mask:0xc
  v_add_f32_dpp v46, v54, v54 row_shr:8 row_mask:0xf bank_mask:0xc
  v_add_f32_dpp v47, v55, v55 row_shr:8 row_mask:0xf bank_mask:0xc
  v_add_f32_dpp v40, v40, v40 row_shl:4 row_mask:0xf bank_mask:0x5
  v_add_f32_dpp v41, v41, v41 row_shl:4 row_mask:0xf bank_mask:0x5
  v_add_f32_dpp v42, v42, v42 row_shl:4 row_mask:0xf bank_mask:0x5
  v_add_f32_dpp v43, v43, v43 row_shl:4 row_mask:0xf bank_mask:0x5
  v_add_f32_dpp v40, v44, v44 row_shr:4 row_mask:0xf bank_mask:0xa
  v_add_f32_dpp v41, v45, v45 row_shr:4 row_mask:0xf bank_mask:0xa
  v_add_f32_dpp v42, v46, v46 row_shr:4 row_mask:0xf bank_mask:0xa
  v_add_f32_dpp v43, v47, v47 row_shr:4 row_mask:0xf bank_mask:0xa
  v_add_f32_dpp v40, v40, v40 quad_perm:[2,3,0,1] row_mask:0xf bank_mask:0xf
  v_add_f32_dpp v41, v41, v41 quad_perm:[2,3,0,1] row_mask:0xf bank_mask:0xf
  v_add_f32_dpp v42, v42, v42 quad_perm:[2,3,0,1] row_mask:0xf bank_mask:0xf
  v_add_f32_dpp v43, v43, v43 quad_perm:[2,3,0,1] row_mask:0xf bank_mask:0xf
  v_cndmask_b32 v40, v40, v42, s[50:51]
  v_cndmask_b32 v41, v41, v43, s[50:51]
  s_nop 0
  v_add_f32_dpp v40, v40, v40 quad_perm:[1,0,3,2] row_mask:0xf bank_mask:0xf
  v_add_f32_dpp v41, v41, v41 quad_perm:[1,0,3,2] row_mask:0xf bank_mask:0xf
  v_mov_b32 v56, v57
  v_mov_b32 v57, v58
  v_mov_b32 v58, v59
  v_mov_b32 v59, v60
  v_mov_b32 v60, v61
  v_mov_b32 v61, v62
  v_mov_b32 v62, v63
  v_cndmask_b32 v40, v40, v41, s[52:53]
  v_cvt_pk_bf16_f32 v40, 0, v40
  v_mul_f32 v40, s54, v40
  v_cvt_pk_bf16_f32 v63, 0, v40
  s_add_u32 s92, s92, 120
  s_waitcnt lgkmcnt(0)
  v_readfirstlane_b32 s63, v31
  s_sub_u32 s93, s94, s92
  s_sub_u32 s43, s63, s93
  s_cmp_eq_u32 s63, 0x80000000
  s_cselect_b32 s43, 0, s43
  s_cselect_b32 s96, s61, 3
  s_cmp_gt_i32 s43, s13
  s_cselect_b32 s96, 2, s96
  s_cmp_lt_i32 s43, s14
  s_cselect_b32 s96, 4, s96
  s_cmp_lt_i32 s43, s15
  s_cselect_b32 s96, 6, s96
  s_mov_b32 s99, 3
  s_branch L_k0_next
L_k3_b4:
  s_waitcnt vmcnt(3)
  s_cmp_gt_u32 s99, 4
  s_cbranch_scc1 L_k3_b4s4
  buffer_load_dwordx4 v[160:163], v2, s[16:19], s97 offen offset:0 nt
L_k3_b4s4:
  s_and_b32 s43, s98, 7
  s_cmp_lg_u32 s43, s3
  s_cbranch_scc1 L_c1_9
  v_subrev_u32 v34, s62, v34
  v_add_u32 v32, 0x1000, v34
  v_cmp_gt_u32 vcc, 0x2000, v32
  s_nop 1
  v_cndmask_b32 v34, 0, v34, vcc
  s_nop 1
  v_add_u32_dpp v34, v34, v34 row_ror:8 row_mask:0xf bank_mask:0xf
  s_nop 1
  v_add_u32_dpp v34, v34, v34 row_ror:4 row_mask:0xf bank_mask:0xf
  s_nop 1
  v_add_u32_dpp v34, v34, v34 row_ror:2 row_mask:0xf bank_mask:0xf
  s_nop 1
  v_add_u32_dpp v34, v34, v34 row_ror:1 row_mask:0xf bank_mask:0xf
  s_nop 0
  v_readlane_b32 s43, v34, 0
  s_nop 0
  s_ashr_i32 s43, s43, 3
  s_add_u32 s43, s43, s62
  v_mov_b32 v32, s43
  ds_write_b32 v33, v32 offset:6208
L_c1_9:
  v_dot2_f32_bf16 v52, v208, v4, 0
  v_dot2_f32_bf16 v52, v209, v5, v52
  v_dot2_f32_bf16 v52, v210, v6, v52
  v_dot2_f32_bf16 v52, v211, v7, v52
  s_waitcnt vmcnt(3)
  s_cmp_gt_u32 s99, 5
  s_cbranch_scc1 L_k3_b4s5
  s_add_u32 s42, s97, 8192
  buffer_load_dwordx4 v[164:167], v2, s[16:19], s42 offen offset:0 nt
L_k3_b4s5:
  v_dot2_f32_bf16 v53, v212, v4, 0
  v_dot2_f32_bf16 v53, v213, v5, v53
  v_dot2_f32_bf16 v53, v214, v6, v53
  v_dot2_f32_bf16 v53, v215, v7, v53
  s_waitcnt vmcnt(3)
  s_add_u32 s42, s97, 16384
  buffer_load_dwordx4 v[168:171], v2, s[16:19], s42 offen offset:0 nt
  s_memrealtime s[94:95]
  ds_read_b32 v31, v33 offset:6208
  v_dot2_f32_bf16 v54, v216, v4, 0
  v_dot2_f32_bf16 v54, v217, v5, v54
  v_dot2_f32_bf16 v54, v218, v6, v54
  v_dot2_f32_bf16 v54, v219, v7, v54
  s_waitcnt vmcnt(3)
  s_add_u32 s42, s97, 24576
  buffer_load_dwordx4 v[172:175], v2, s[16:19], s42 offen offset:0 nt
  v_dot2_f32_bf16 v55, v220, v4, 0
  v_dot2_f32_bf16 v55, v221, v5, v55
  v_dot2_f32_bf16 v55, v222, v6, v55
  v_dot2_f32_bf16 v55, v223, v7, v55
  v_add_f32_dpp v40, v40, v40 row_shl:8 row_mask:0xf bank_mask:0x3
  v_add_f32_dpp v41, v41, v41 row_shl:8 row_mask:0xf bank_mask:0x3
  v_add_f32_dpp v42, v42, v42 row_shl:8 row_mask:0xf bank_mask:0x3
  v_add_f32_dpp v43, v43, v43 row_shl:8 row_mask:0xf bank_mask:0x3
  v_add_f32_dpp v44, v44, v44 row_shl:8 row_mask:0xf bank_mask:0x3
  v_add_f32_dpp v45, v45, v45 row_shl:8 row_mask:0xf bank_mask:0x3
  v_add_f32_dpp v46, v46, v46 row_shl:8 row_mask:0xf bank_mask:0x3
  v_add_f32_dpp v47, v47, v47 row_shl:8 row_mask:0xf bank_mask:0x3
  v_add_f32_dpp v40, v48, v48 row_shr:8 row_mask:0xf bank_mask:0xc
  v_add_f32_dpp v41, v49, v49 row_shr:8 row_mask:0xf bank_mask:0xc
  v_add_f32_dpp v42, v50, v50 row_shr:8 row_mask:0xf bank_mask:0xc
  v_add_f32_dpp v43, v51, v51 row_shr:8 row_mask:0xf bank_mask:0xc
  v_add_f32_dpp v44, v52, v52 row_shr:8 row_mask:0xf bank_mask:0xc
  v_add_f32_dpp v45, v53, v53 row_shr:8 row_mask:0xf bank_mask:0xc
  v_add_f32_dpp v46, v54, v54 row_shr:8 row_mask:0xf bank_mask:0xc
  v_add_f32_dpp v47, v55, v55 row_shr:8 row_mask:0xf bank_mask:0xc
  v_add_f32_dpp v40, v40, v40 row_shl:4 row_mask:0xf bank_mask:0x5
  v_add_f32_dpp v41, v41, v41 row_shl:4 row_mask:0xf bank_mask:0x5
  v_add_f32_dpp v42, v42, v42 row_shl:4 row_mask:0xf bank_mask:0x5
  v_add_f32_dpp v43, v43, v43 row_shl:4 row_mask:0xf bank_mask:0x5
  v_add_f32_dpp v40, v44, v44 row_shr:4 row_mask:0xf bank_mask:0xa
  v_add_f32_dpp v41, v45, v45 row_shr:4 row_mask:0xf bank_mask:0xa
  v_add_f32_dpp v42, v46, v46 row_shr:4 row_mask:0xf bank_mask:0xa
  v_add_f32_dpp v43, v47, v47 row_shr:4 row_mask:0xf bank_mask:0xa
  v_add_f32_dpp v40, v40, v40 quad_perm:[2,3,0,1] row_mask:0xf bank_mask:0xf
  v_add_f32_dpp v41, v41, v41 quad_perm:[2,3,0,1] row_mask:0xf bank_mask:0xf
  v_add_f32_dpp v42, v42, v42 quad_perm:[2,3,0,1] row_mask:0xf bank_mask:0xf
  v_add_f32_dpp v43, v43, v43 quad_perm:[2,3,0,1] row_mask:0xf bank_mask:0xf
  v_cndmask_b32 v40, v40, v42, s[50:51]
  v_cndmask_b32 v41, v41, v43, s[50:51]
  s_nop 0
  v_add_f32_dpp v40, v40, v40 quad_perm:[1,0,3,2] row_mask:0xf bank_mask:0xf
  v_add_f32_dpp v41, v41, v41 quad_perm:[1,0,3,2] row_mask:0xf bank_mask:0xf
  v_mov_b32 v56, v57
  v_mov_b32 v57, v58
  v_mov_b32 v58, v59
  v_mov_b32 v59, v60
  v_mov_b32 v60, v61
  v_mov_b32 v61, v62
  v_mov_b32 v62, v63
  v_cndmask_b32 v40, v40, v41, s[52:53]
  v_cvt_pk_bf16_f32 v40, 0, v40
  v_mul_f32 v40, s54, v40
  v_cvt_pk_bf16_f32 v63, 0, v40
  s_add_u32 s92, s92, 120
  s_waitcnt lgkmcnt(0)
  v_readfirstlane_b32 s63, v31
  s_sub_u32 s93, s94, s92
  s_sub_u32 s43, s63, s93
  s_cmp_eq_u32 s63, 0x80000000
  s_cselect_b32 s43, 0, s43
  s_cselect_b32 s96, s61, 3
  s_cmp_gt_i32 s43, s13
  s_cselect_b32 s96, 2, s96
  s_cmp_lt_i32 s43, s14
  s_cselect_b32 s96, 4, s96
  s_cmp_lt_i32 s43, s15
  s_cselect_b32 s96, 6, s96
  s_mov_b32 s99, 4
  s_branch L_k0_next
L_k3_b6:
  s_waitcnt vmcnt(5)
  s_add_u32 s42, s97, 16384
  buffer_load_dwordx4 v[168:171], v2, s[16:19], s42 offen offset:0 nt
  s_and_b32 s43, s98, 7
  s_cmp_lg_u32 s43, s3
  s_cbranch_scc1 L_c1_10
  v_subrev_u32 v34, s62, v34
  v_add_u32 v32, 0x1000, v34
  v_cmp_gt_u32 vcc, 0x2000, v32
  s_nop 1
  v_cndmask_b32 v34, 0, v34, vcc
  s_nop 1
  v_add_u32_dpp v34, v34, v34 row_ror:8 row_mask:0xf bank_mask:0xf
  s_nop 1
  v_add_u32_dpp v34, v34, v34 row_ror:4 row_mask:0xf bank_mask:0xf
  s_nop 1
  v_add_u32_dpp v34, v34, v34 row_ror:2 row_mask:0xf bank_mask:0xf
  s_nop 1
  v_add_u32_dpp v34, v34, v34 row_ror:1 row_mask:0xf bank_mask:0xf
  s_nop 0
  v_readlane_b32 s43, v34, 0
  s_nop 0
  s_ashr_i32 s43, s43, 3
  s_add_u32 s43, s43, s62
  v_mov_b32 v32, s43
  ds_write_b32 v33, v32 offset:6208
L_c1_10:
  v_dot2_f32_bf16 v52, v208, v4, 0
  v_dot2_f32_bf16 v52, v209, v5, v52
  v_dot2_f32_bf16 v52, v210, v6, v52
  v_dot2_f32_bf16 v52, v211, v7, v52
  s_waitcnt vmcnt(5)
  s_add_u32 s42, s97, 24576
  buffer_load_dwordx4 v[172:175], v2, s[16:19], s42 offen offset:0 nt
  v_dot2_f32_bf16 v53, v212, v4, 0
  v_dot2_f32_bf16 v53, v213, v5, v53
  v_dot2_f32_bf16 v53, v214, v6, v53
  v_dot2_f32_bf16 v53, v215, v7, v53
  s_waitcnt vmcnt(5)
  s_add_u32 s42, s97, 32768
  buffer_load_dwordx4 v[176:179], v2, s[16:19], s42 offen offset:0 nt
  s_memrealtime s[94:95]
  ds_read_b32 v31, v33 offset:6208
  v_dot2_f32_bf16 v54, v216, v4, 0
  v_dot2_f32_bf16 v54, v217, v5, v54
  v_dot2_f32_bf16 v54, v218, v6, v54
  v_dot2_f32_bf16 v54, v219, v7, v54
  s_waitcnt vmcnt(5)
  s_add_u32 s42, s97, 40960
  buffer_load_dwordx4 v[180:183], v2, s[16:19], s42 offen offset:0 nt
  v_dot2_f32_bf16 v55, v220, v4, 0
  v_dot2_f32_bf16 v55, v221, v5, v55
  v_dot2_f32_bf16 v55, v222, v6, v55
  v_dot2_f32_bf16 v55, v223, v7, v55
  v_add_f32_dpp v40, v40, v40 row_shl:8 row_mask:0xf bank_mask:0x3
  v_add_f32_dpp v41, v41, v41 row_shl:8 row_mask:0xf bank_mask:0x3
  v_add_f32_dpp v42, v42, v42 row_shl:8 row_mask:0xf bank_mask:0x3
  v_add_f32_dpp v43, v43, v43 row_shl:8 row_mask:0xf bank_mask:0x3
  v_add_f32_dpp v44, v44, v44 row_shl:8 row_mask:0xf bank_mask:0x3
  v_add_f32_dpp v45, v45, v45 row_shl:8 row_mask:0xf bank_mask:0x3
  v_add_f32_dpp v46, v46, v46 row_shl:8 row_mask:0xf bank_mask:0x3
  v_add_f32_dpp v47, v47, v47 row_shl:8 row_mask:0xf bank_mask:0x3
  v_add_f32_dpp v40, v48, v48 row_shr:8 row_mask:0xf bank_mask:0xc
  v_add_f32_dpp v41, v49, v49 row_shr:8 row_mask:0xf bank_mask:0xc
  v_add_f32_dpp v42, v50, v50 row_shr:8 row_mask:0xf bank_mask:0xc
  v_add_f32_dpp v43, v51, v51 row_shr:8 row_mask:0xf bank_mask:0xc
  v_add_f32_dpp v44, v52, v52 row_shr:8 row_mask:0xf bank_mask:0xc
  v_add_f32_dpp v45, v53, v53 row_shr:8 row_mask:0xf bank_mask:0xc
  v_add_f32_dpp v46, v54, v54 row_shr:8 row_mask:0xf bank_mask:0xc
  v_add_f32_dpp v47, v55, v55 row_shr:8 row_mask:0xf bank_mask:0xc
  v_add_f32_dpp v40, v40, v40 row_shl:4 row_mask:0xf bank_mask:0x5
  v_add_f32_dpp v41, v41, v41 row_shl:4 row_mask:0xf bank_mask:0x5
  v_add_f32_dpp v42, v42, v42 row_shl:4 row_mask:0xf bank_mask:0x5
  v_add_f32_dpp v43, v43, v43 row_shl:4 row_mask:0xf bank_mask:0x5
  v_add_f32_dpp v40, v44, v44 row_shr:4 row_mask:0xf bank_mask:0xa
  v_add_f32_dpp v41, v45, v45 row_shr:4 row_mask:0xf bank_mask:0xa
  v_add_f32_dpp v42, v46, v46 row_shr:4 row_mask:0xf bank_mask:0xa
  v_add_f32_dpp v43, v47, v47 row_shr:4 row_mask:0xf bank_mask:0xa
  v_add_f32_dpp v40, v40, v40 quad_perm:[2,3,0,1] row_mask:0xf bank_mask:0xf
  v_add_f32_dpp v41, v41, v41 quad_perm:[2,3,0,1] row_mask:0xf bank_mask:0xf
  v_add_f32_dpp v42, v42, v42 quad_perm:[2,3,0,1] row_mask:0xf bank_mask:0xf
  v_add_f32_dpp v43, v43, v43 quad_perm:[2,3,0,1] row_mask:0xf bank_mask:0xf
  v_cndmask_b32 v40, v40, v42, s[50:51]
  v_cndmask_b32 v41, v41, v43, s[50:51]
  s_nop 0
  v_add_f32_dpp v40, v40, v40 quad_perm:[1,0,3,2] row_mask:0xf bank_mask:0xf
  v_add_f32_dpp v41, v41, v41 quad_perm:[1,0,3,2] row_mask:0xf bank_mask:0xf
  v_mov_b32 v56, v57
  v_mov_b32 v57, v58
  v_mov_b32 v58, v59
  v_mov_b32 v59, v60
  v_mov_b32 v60, v61
  v_mov_b32 v61, v62
  v_mov_b32 v62, v63
  v_cndmask_b32 v40, v40, v41, s[52:53]
  v_cvt_pk_bf16_f32 v40, 0, v40
  v_mul_f32 v40, s54, v40
  v_cvt_pk_bf16_f32 v63, 0, v40
  s_add_u32 s92, s92, 120
  s_waitcnt lgkmcnt(0)
  v_readfirstlane_b32 s63, v31
  s_sub_u32 s93, s94, s92
  s_sub_u32 s43, s63, s93
  s_cmp_eq_u32 s63, 0x80000000
  s_cselect_b32 s43, 0, s43
  s_cselect_b32 s96, s61, 3
  s_cmp_gt_i32 s43, s13
  s_cselect_b32 s96, 2, s96
  s_cmp_lt_i32 s43, s14
  s_cselect_b32 s96, 4, s96
  s_cmp_lt_i32 s43, s15
  s_cselect_b32 s96, 6, s96
  s_mov_b32 s99, 6
  s_branch L_k0_next
L_k_done:
  s_cmp_gt_u32 s99, 2
  s_cbranch_scc1 L_x2
  s_mov_b32 s42, 16384
  buffer_load_dwordx4 v[168:171], v2, s[8:11], s42 offen offset:0 nt
L_x2:
  s_cmp_gt_u32 s99, 3
  s_cbranch_scc1 L_x3
  s_mov_b32 s42, 24576
  buffer_load_dwordx4 v[172:175], v2, s[8:11], s42 offen offset:0 nt
L_x3:
  s_cmp_gt_u32 s99, 4
  s_cbranch_scc1 L_x4
  s_mov_b32 s42, 32768
  buffer_load_dwordx4 v[176:179], v2, s[8:11], s42 offen offset:0 nt
L_x4:
  s_cmp_gt_u32 s99, 5
  s_cbranch_scc1 L_x5
  s_mov_b32 s42, 40960
  buffer_load_dwordx4 v[180:183], v2, s[8:11], s42 offen offset:0 nt
L_x5:
  s_mov_b32 s42, 49152
  buffer_load_dwordx4 v[184:187], v2, s[8:11], s42 offen offset:0 nt
  v_mov_b32 v244, 0
  global_load_dword v251, v244, s[84:85] sc1
  v_max3_f32 v224, v56, v57, v58
  v_max3_f32 v224, v224, v59, v60
  v_max3_f32 v224, v224, v61, v62
  v_max_f32 v224, v224, v63
  s_nop 1
  v_max_f32_dpp v224, v224, v224 row_ror:8 row_mask:0xf bank_mask:0xf
  s_nop 1
  v_max_f32_dpp v224, v224, v224 row_ror:4 row_mask:0xf bank_mask:0xf
  s_nop 1
  v_max_f32_dpp v224, v224, v224 row_ror:2 row_mask:0xf bank_mask:0xf
  s_nop 1
  v_max_f32_dpp v224, v224, v224 row_ror:1 row_mask:0xf bank_mask:0xf
  v_mov_b32 v252, v224
  s_nop 1
  v_permlane16_swap_b32 v224, v252
  v_max_f32 v224, v224, v252
  v_mov_b32 v252, v224
  s_nop 1
  v_permlane32_swap_b32 v224, v252
  v_max_f32 v224, v224, v252
  v_sub_f32 v56, v56, v224
  v_mul_f32 v56, s55, v56
  v_sub_f32 v57, v57, v224
  v_mul_f32 v57, s55, v57
  v_sub_f32 v58, v58, v224
  v_mul_f32 v58, s55, v58
  v_sub_f32 v59, v59, v224
  v_mul_f32 v59, s55, v59
  v_sub_f32 v60, v60, v224
  v_mul_f32 v60, s55, v60
  v_sub_f32 v61, v61, v224
  v_mul_f32 v61, s55, v61
  v_sub_f32 v62, v62, v224
  v_mul_f32 v62, s55, v62
  v_sub_f32 v63, v63, v224
  v_mul_f32 v63, s55, v63
  v_exp_f32 v56, v56
  v_exp_f32 v57, v57
  v_exp_f32 v58, v58
  v_exp_f32 v59, v59
  v_exp_f32 v60, v60
  v_exp_f32 v61, v61
  v_exp_f32 v62, v62
  v_exp_f32 v63, v63
  v_add_f32 v225, v56, v57
  v_add_f32 v225, v225, v58
  v_add_f32 v225, v225, v59
  v_add_f32 v225, v225, v60
  v_add_f32 v225, v225, v61
  v_add_f32 v225, v225, v62
  v_add_f32 v225, v225, v63
  s_nop 1
  v_add_f32_dpp v225, v225, v225 row_ror:8 row_mask:0xf bank_mask:0xf
  s_nop 1
  v_add_f32_dpp v225, v225, v225 row_ror:4 row_mask:0xf bank_mask:0xf
  s_nop 1
  v_add_f32_dpp v225, v225, v225 row_ror:2 row_mask:0xf bank_mask:0xf
  s_nop 1
  v_add_f32_dpp v225, v225, v225 row_ror:1 row_mask:0xf bank_mask:0xf
  v_mov_b32 v252, v225
  s_nop 1
  v_permlane16_swap_b32 v225, v252
  v_add_f32 v225, v225, v252
  v_mov_b32 v252, v225
  s_nop 1
  v_permlane32_swap_b32 v225, v252
  v_add_f32 v225, v225, v252
  s_lshl_b32 s42, s3, 3
  v_mov_b32 v226, s42
  ds_write_b64 v226, v[224:225] offset:6144
  s_waitcnt lgkmcnt(0)
  s_barrier
  v_mov_b32 v226, 0
  ds_read_b128 v[228:231], v226 offset:6144
  ds_read_b128 v[232:235], v226 offset:6160
  ds_read_b128 v[236:239], v226 offset:6176
  ds_read_b128 v[240:243], v226 offset:6192
  s_waitcnt lgkmcnt(0)
  v_max3_f32 v226, v228, v230, v232
  v_max3_f32 v226, v226, v234, v236
  v_max3_f32 v226, v226, v238, v240
  v_max_f32 v226, v226, v242
  v_sub_f32 v228, v228, v226
  v_mul_f32 v228, s55, v228
  v_sub_f32 v230, v230, v226
  v_mul_f32 v230, s55, v230
  v_sub_f32 v232, v232, v226
  v_mul_f32 v232, s55, v232
  v_sub_f32 v234, v234, v226
  v_mul_f32 v234, s55, v234
  v_sub_f32 v236, v236, v226
  v_mul_f32 v236, s55, v236
  v_sub_f32 v238, v238, v226
  v_mul_f32 v238, s55, v238
  v_sub_f32 v240, v240, v226
  v_mul_f32 v240, s55, v240
  v_sub_f32 v242, v242, v226
  v_mul_f32 v242, s55, v242
  v_sub_f32 v224, v224, v226
  v_mul_f32 v224, s55, v224
  v_exp_f32 v228, v228
  v_exp_f32 v230, v230
  v_exp_f32 v232, v232
  v_exp_f32 v234, v234
  v_exp_f32 v236, v236
  v_exp_f32 v238, v238
  v_exp_f32 v240, v240
  v_exp_f32 v242, v242
  v_exp_f32 v224, v224
  v_mul_f32 v227, v228, v229
  v_fmac_f32 v227, v230, v231
  v_fmac_f32 v227, v232, v233
  v_fmac_f32 v227, v234, v235
  v_fmac_f32 v227, v236, v237
  v_fmac_f32 v227, v238, v239
  v_fmac_f32 v227, v240, v241
  v_fmac_f32 v227, v242, v243
  v_rcp_f32 v227, v227
  s_nop 0
  v_mul_f32 v224, v224, v227
  v_mul_f32 v56, v56, v224
  v_mul_f32 v57, v57, v224
  v_mul_f32 v58, v58, v224
  v_mul_f32 v59, v59, v224
  v_mul_f32 v60, v60, v224
  v_mul_f32 v61, v61, v224
  v_mul_f32 v62, v62, v224
  v_mul_f32 v63, v63, v224
  v_cvt_pk_bf16_f32 v56, v56, 0
  v_cvt_pk_bf16_f32 v57, v57, 0
  v_cvt_pk_bf16_f32 v58, v58, 0
  v_cvt_pk_bf16_f32 v59, v59, 0
  v_cvt_pk_bf16_f32 v60, v60, 0
  v_cvt_pk_bf16_f32 v61, v61, 0
  v_cvt_pk_bf16_f32 v62, v62, 0
  v_cvt_pk_bf16_f32 v63, v63, 0
  v_lshlrev_b32 v64, 16, v56
  v_lshlrev_b32 v65, 16, v57
  v_lshlrev_b32 v66, 16, v58
  v_lshlrev_b32 v67, 16, v59
  v_lshlrev_b32 v68, 16, v60
  v_lshlrev_b32 v69, 16, v61
  v_lshlrev_b32 v70, 16, v62
  v_lshlrev_b32 v71, 16, v63
  v_mov_b32 v72, 0
  v_mov_b32 v73, 0
  v_mov_b32 v74, 0
  v_mov_b32 v75, 0
  v_mov_b32 v76, 0
  v_mov_b32 v77, 0
  v_mov_b32 v78, 0
  v_mov_b32 v79, 0
  s_waitcnt vmcnt(7)
  s_and_b32 s43, s98, 7
  s_cmp_lg_u32 s43, s3
  s_cbranch_scc1 L_c0_11
  v_mov_b32 v32, s93
  s_mov_b32 s62, s93
  s_mul_i32 s47, s98, 8192
  buffer_store_dword v32, v36, s[24:27], s47 offen sc1
  s_lshr_b32 s43, s2, 3
  s_mul_i32 s47, s98, 5
  s_add_u32 s43, s43, s47
  s_and_b32 s43, s43, 3
  s_mul_i32 s43, s43, 2048
  s_add_u32 s43, s43, 1048576
  s_sub_u32 s47, s98, 1
  s_max_i32 s47, s47, 0
  s_mul_i32 s47, s47, 8192
  s_add_u32 s43, s43, s47
  buffer_load_dword v34, v35, s[24:27], s43 offen
L_c0_11:
  v_dot2c_f32_bf16_dpp v72, v56, v160 row_newbcast:0 row_mask:0xf bank_mask:0xf
  v_dot2c_f32_bf16_dpp v73, v64, v160 row_newbcast:0 row_mask:0xf bank_mask:0xf
  v_dot2c_f32_bf16_dpp v74, v56, v161 row_newbcast:0 row_mask:0xf bank_mask:0xf
  v_dot2c_f32_bf16_dpp v75, v64, v161 row_newbcast:0 row_mask:0xf bank_mask:0xf
  v_dot2c_f32_bf16_dpp v76, v56, v162 row_newbcast:0 row_mask:0xf bank_mask:0xf
  v_dot2c_f32_bf16_dpp v77, v64, v162 row_newbcast:0 row_mask:0xf bank_mask:0xf
  v_dot2c_f32_bf16_dpp v78, v56, v163 row_newbcast:0 row_mask:0xf bank_mask:0xf
  v_dot2c_f32_bf16_dpp v79, v64, v163 row_newbcast:0 row_mask:0xf bank_mask:0xf
  s_waitcnt vmcnt(6)
  v_dot2c_f32_bf16_dpp v72, v56, v164 row_newbcast:1 row_mask:0xf bank_mask:0xf
  v_dot2c_f32_bf16_dpp v73, v64, v164 row_newbcast:1 row_mask:0xf bank_mask:0xf
  v_dot2c_f32_bf16_dpp v74, v56, v165 row_newbcast:1 row_mask:0xf bank_mask:0xf
  v_dot2c_f32_bf16_dpp v75, v64, v165 row_newbcast:1 row_mask:0xf bank_mask:0xf
  v_dot2c_f32_bf16_dpp v76, v56, v166 row_newbcast:1 row_mask:0xf bank_mask:0xf
  v_dot2c_f32_bf16_dpp v77, v64, v166 row_newbcast:1 row_mask:0xf bank_mask:0xf
  v_dot2c_f32_bf16_dpp v78, v56, v167 row_newbcast:1 row_mask:0xf bank_mask:0xf
  v_dot2c_f32_bf16_dpp v79, v64, v167 row_newbcast:1 row_mask:0xf bank_mask:0xf
  s_waitcnt vmcnt(5)
  v_dot2c_f32_bf16_dpp v72, v56, v168 row_newbcast:2 row_mask:0xf bank_mask:0xf
  v_dot2c_f32_bf16_dpp v73, v64, v168 row_newbcast:2 row_mask:0xf bank_mask:0xf
  v_dot2c_f32_bf16_dpp v74, v56, v169 row_newbcast:2 row_mask:0xf bank_mask:0xf
  v_dot2c_f32_bf16_dpp v75, v64, v169 row_newbcast:2 row_mask:0xf bank_mask:0xf
  v_dot2c_f32_bf16_dpp v76, v56, v170 row_newbcast:2 row_mask:0xf bank_mask:0xf
  v_dot2c_f32_bf16_dpp v77, v64, v170 row_newbcast:2 row_mask:0xf bank_mask:0xf
  v_dot2c_f32_bf16_dpp v78, v56, v171 row_newbcast:2 row_mask:0xf bank_mask:0xf
  v_dot2c_f32_bf16_dpp v79, v64, v171 row_newbcast:2 row_mask:0xf bank_mask:0xf
  s_waitcnt vmcnt(4)
  v_dot2c_f32_bf16_dpp v72, v56, v172 row_newbcast:3 row_mask:0xf bank_mask:0xf
  v_dot2c_f32_bf16_dpp v73, v64, v172 row_newbcast:3 row_mask:0xf bank_mask:0xf
  v_dot2c_f32_bf16_dpp v74, v56, v173 row_newbcast:3 row_mask:0xf bank_mask:0xf
  v_dot2c_f32_bf16_dpp v75, v64, v173 row_newbcast:3 row_mask:0xf bank_mask:0xf
  v_dot2c_f32_bf16_dpp v76, v56, v174 row_newbcast:3 row_mask:0xf bank_mask:0xf
  v_dot2c_f32_bf16_dpp v77, v64, v174 row_newbcast:3 row_mask:0xf bank_mask:0xf
  v_dot2c_f32_bf16_dpp v78, v56, v175 row_newbcast:3 row_mask:0xf bank_mask:0xf
  v_dot2c_f32_bf16_dpp v79, v64, v175 row_newbcast:3 row_mask:0xf bank_mask:0xf
  s_waitcnt vmcnt(3)
  s_mov_b32 s42, 57344
  buffer_load_dwordx4 v[188:191], v2, s[8:11], s42 offen offset:0 nt
  v_dot2c_f32_bf16_dpp v72, v56, v176 row_newbcast:4 row_mask:0xf bank_mask:0xf
  v_dot2c_f32_bf16_dpp v73, v64, v176 row_newbcast:4 row_mask:0xf bank_mask:0xf
  v_dot2c_f32_bf16_dpp v74, v56, v177 row_newbcast:4 row_mask:0xf bank_mask:0xf
  v_dot2c_f32_bf16_dpp v75, v64, v177 row_newbcast:4 row_mask:0xf bank_mask:0xf
  v_dot2c_f32_bf16_dpp v76, v56, v178 row_newbcast:4 row_mask:0xf bank_mask:0xf
  v_dot2c_f32_bf16_dpp v77, v64, v178 row_newbcast:4 row_mask:0xf bank_mask:0xf
  v_dot2c_f32_bf16_dpp v78, v56, v179 row_newbcast:4 row_mask:0xf bank_mask:0xf
  v_dot2c_f32_bf16_dpp v79, v64, v179 row_newbcast:4 row_mask:0xf bank_mask:0xf
  s_waitcnt vmcnt(3)
  s_mov_b32 s42, 65536
  buffer_load_dwordx4 v[192:195], v2, s[8:11], s42 offen offset:0 nt
  v_dot2c_f32_bf16_dpp v72, v56, v180 row_newbcast:5 row_mask:0xf bank_mask:0xf
  v_dot2c_f32_bf16_dpp v73, v64, v180 row_newbcast:5 row_mask:0xf bank_mask:0xf
  v_dot2c_f32_bf16_dpp v74, v56, v181 row_newbcast:5 row_mask:0xf bank_mask:0xf
  v_dot2c_f32_bf16_dpp v75, v64, v181 row_newbcast:5 row_mask:0xf bank_mask:0xf
  v_dot2c_f32_bf16_dpp v76, v56, v182 row_newbcast:5 row_mask:0xf bank_mask:0xf
  v_dot2c_f32_bf16_dpp v77, v64, v182 row_newbcast:5 row_mask:0xf bank_mask:0xf
  v_dot2c_f32_bf16_dpp v78, v56, v183 row_newbcast:5 row_mask:0xf bank_mask:0xf
  v_dot2c_f32_bf16_dpp v79, v64, v183 row_newbcast:5 row_mask:0xf bank_mask:0xf
  s_waitcnt vmcnt(3)
  s_mov_b32 s42, 73728
  buffer_load_dwordx4 v[196:199], v2, s[8:11], s42 offen offset:0 nt
  v_dot2c_f32_bf16_dpp v72, v56, v184 row_newbcast:6 row_mask:0xf bank_mask:0xf
  v_dot2c_f32_bf16_dpp v73, v64, v184 row_newbcast:6 row_mask:0xf bank_mask:0xf
  v_dot2c_f32_bf16_dpp v74, v56, v185 row_newbcast:6 row_mask:0xf bank_mask:0xf
  v_dot2c_f32_bf16_dpp v75, v64, v185 row_newbcast:6 row_mask:0xf bank_mask:0xf
  v_dot2c_f32_bf16_dpp v76, v56, v186 row_newbcast:6 row_mask:0xf bank_mask:0xf
  v_dot2c_f32_bf16_dpp v77, v64, v186 row_newbcast:6 row_mask:0xf bank_mask:0xf
  v_dot2c_f32_bf16_dpp v78, v56, v187 row_newbcast:6 row_mask:0xf bank_mask:0xf
  v_dot2c_f32_bf16_dpp v79, v64, v187 row_newbcast:6 row_mask:0xf bank_mask:0xf
  s_waitcnt vmcnt(2)
  s_mov_b32 s42, 81920
  buffer_load_dwordx4 v[200:203], v2, s[8:11], s42 offen offset:0 nt
  v_dot2c_f32_bf16_dpp v72, v56, v188 row_newbcast:7 row_mask:0xf bank_mask:0xf
  v_dot2c_f32_bf16_dpp v73, v64, v188 row_newbcast:7 row_mask:0xf bank_mask:0xf
  v_dot2c_f32_bf16_dpp v74, v56, v189 row_newbcast:7 row_mask:0xf bank_mask:0xf
  v_dot2c_f32_bf16_dpp v75, v64, v189 row_newbcast:7 row_mask:0xf bank_mask:0xf
  v_dot2c_f32_bf16_dpp v76, v56, v190 row_newbcast:7 row_mask:0xf bank_mask:0xf
  v_dot2c_f32_bf16_dpp v77, v64, v190 row_newbcast:7 row_mask:0xf bank_mask:0xf
  v_dot2c_f32_bf16_dpp v78, v56, v191 row_newbcast:7 row_mask:0xf bank_mask:0xf
  v_dot2c_f32_bf16_dpp v79, v64, v191 row_newbcast:7 row_mask:0xf bank_mask:0xf
  s_waitcnt vmcnt(2)
  s_mov_b32 s42, 90112
  buffer_load_dwordx4 v[204:207], v2, s[8:11], s42 offen offset:0 nt
  s_lshl_b32 s47, s90, 10
  s_add_u32 s43, s47, s91
  s_mul_i32 s47, s90, s46
  s_bitcmp1_b32 s37, s98
  s_cselect_b32 m0, s43, s36
  s_cselect_b32 s22, s60, 0
  s_cselect_b32 s43, 1, 0
  buffer_load_dwordx4 v39, s[20:23], s47 offen  lds
  s_add_u32 s90, s90, s43
  s_or_b32 s43, s3, s101
  s_cbranch_scc1 L_v0s
  s_mov_b32 s41, 0
L_v0l:
  v_readfirstlane_b32 s43, v251
  s_nop 0
  s_cmp_ge_u32 s43, 256
  s_cbranch_scc1 L_v0k
  s_add_u32 s41, s41, 1
  s_cmp_gt_u32 s41, 2000
  s_cbranch_scc1 L_v0t
  global_load_dword v251, v244, s[84:85] sc1
  s_waitcnt vmcnt(0)
  s_branch L_v0l
L_v0t:
  v_mov_b32 v228, 1
  ds_write_b32 v33, v228 offset:6244
L_v0k:
  v_mov_b32 v227, v123
  s_lshl_b32 s43, s39, 6
  s_add_u32 s43, s43, 159744
  s_mov_b64 exec, 0xff
  buffer_load_dwordx2 v[226:227], v247, s[24:27], s43 offen sc1
  s_mov_b64 exec, -1
L_v0s:
  v_dot2c_f32_bf16_dpp v72, v56, v192 row_newbcast:8 row_mask:0xf bank_mask:0xf
  v_dot2c_f32_bf16_dpp v73, v64, v192 row_newbcast:8 row_mask:0xf bank_mask:0xf
  v_dot2c_f32_bf16_dpp v74, v56, v193 row_newbcast:8 row_mask:0xf bank_mask:0xf
  v_dot2c_f32_bf16_dpp v75, v64, v193 row_newbcast:8 row_mask:0xf bank_mask:0xf
  v_dot2c_f32_bf16_dpp v76, v56, v194 row_newbcast:8 row_mask:0xf bank_mask:0xf
  v_dot2c_f32_bf16_dpp v77, v64, v194 row_newbcast:8 row_mask:0xf bank_mask:0xf
  v_dot2c_f32_bf16_dpp v78, v56, v195 row_newbcast:8 row_mask:0xf bank_mask:0xf
  v_dot2c_f32_bf16_dpp v79, v64, v195 row_newbcast:8 row_mask:0xf bank_mask:0xf
  s_waitcnt vmcnt(3)
  s_mov_b32 s42, 98304
  buffer_load_dwordx4 v[208:211], v2, s[8:11], s42 offen offset:0 nt
  v_dot2c_f32_bf16_dpp v72, v56, v196 row_newbcast:9 row_mask:0xf bank_mask:0xf
  v_dot2c_f32_bf16_dpp v73, v64, v196 row_newbcast:9 row_mask:0xf bank_mask:0xf
  v_dot2c_f32_bf16_dpp v74, v56, v197 row_newbcast:9 row_mask:0xf bank_mask:0xf
  v_dot2c_f32_bf16_dpp v75, v64, v197 row_newbcast:9 row_mask:0xf bank_mask:0xf
  v_dot2c_f32_bf16_dpp v76, v56, v198 row_newbcast:9 row_mask:0xf bank_mask:0xf
  v_dot2c_f32_bf16_dpp v77, v64, v198 row_newbcast:9 row_mask:0xf bank_mask:0xf
  v_dot2c_f32_bf16_dpp v78, v56, v199 row_newbcast:9 row_mask:0xf bank_mask:0xf
  v_dot2c_f32_bf16_dpp v79, v64, v199 row_newbcast:9 row_mask:0xf bank_mask:0xf
  s_waitcnt vmcnt(3)
  s_mov_b32 s42, 106496
  buffer_load_dwordx4 v[212:215], v2, s[8:11], s42 offen offset:0 nt
  s_and_b32 s43, s98, 7
  s_cmp_lg_u32 s43, s3
  s_cbranch_scc1 L_c1_12
  v_subrev_u32 v34, s62, v34
  v_add_u32 v32, 0x1000, v34
  v_cmp_gt_u32 vcc, 0x2000, v32
  s_nop 1
  v_cndmask_b32 v34, 0, v34, vcc
  s_nop 1
  v_add_u32_dpp v34, v34, v34 row_ror:8 row_mask:0xf bank_mask:0xf
  s_nop 1
  v_add_u32_dpp v34, v34, v34 row_ror:4 row_mask:0xf bank_mask:0xf
  s_nop 1
  v_add_u32_dpp v34, v34, v34 row_ror:2 row_mask:0xf bank_mask:0xf
  s_nop 1
  v_add_u32_dpp v34, v34, v34 row_ror:1 row_mask:0xf bank_mask:0xf
  s_nop 0
  v_readlane_b32 s43, v34, 0
  s_nop 0
  s_ashr_i32 s43, s43, 3
  s_add_u32 s43, s43, s62
  v_mov_b32 v32, s43
  ds_write_b32 v33, v32 offset:6208
L_c1_12:
  v_dot2c_f32_bf16_dpp v72, v56, v200 row_newbcast:10 row_mask:0xf bank_mask:0xf
  v_dot2c_f32_bf16_dpp v73, v64, v200 row_newbcast:10 row_mask:0xf bank_mask:0xf
  v_dot2c_f32_bf16_dpp v74, v56, v201 row_newbcast:10 row_mask:0xf bank_mask:0xf
  v_dot2c_f32_bf16_dpp v75, v64, v201 row_newbcast:10 row_mask:0xf bank_mask:0xf
  v_dot2c_f32_bf16_dpp v76, v56, v202 row_newbcast:10 row_mask:0xf bank_mask:0xf
  v_dot2c_f32_bf16_dpp v77, v64, v202 row_newbcast:10 row_mask:0xf bank_mask:0xf
  v_dot2c_f32_bf16_dpp v78, v56, v203 row_newbcast:10 row_mask:0xf bank_mask:0xf
  v_dot2c_f32_bf16_dpp v79, v64, v203 row_newbcast:10 row_mask:0xf bank_mask:0xf
  s_waitcnt vmcnt(3)
  s_mov_b32 s42, 114688
  buffer_load_dwordx4 v[216:219], v2, s[8:11], s42 offen offset:0 nt
  v_dot2c_f32_bf16_dpp v72, v56, v204 row_newbcast:11 row_mask:0xf bank_mask:0xf
  v_dot2c_f32_bf16_dpp v73, v64, v204 row_newbcast:11 row_mask:0xf bank_mask:0xf
  v_dot2c_f32_bf16_dpp v74, v56, v205 row_newbcast:11 row_mask:0xf bank_mask:0xf
  v_dot2c_f32_bf16_dpp v75, v64, v205 row_newbcast:11 row_mask:0xf bank_mask:0xf
  v_dot2c_f32_bf16_dpp v76, v56, v206 row_newbcast:11 row_mask:0xf bank_mask:0xf
  v_dot2c_f32_bf16_dpp v77, v64, v206 row_newbcast:11 row_mask:0xf bank_mask:0xf
  v_dot2c_f32_bf16_dpp v78, v56, v207 row_newbcast:11 row_mask:0xf bank_mask:0xf
  v_dot2c_f32_bf16_dpp v79, v64, v207 row_newbcast:11 row_mask:0xf bank_mask:0xf
  s_waitcnt vmcnt(2)
  s_mov_b32 s42, 122880
  buffer_load_dwordx4 v[220:223], v2, s[8:11], s42 offen offset:0 nt
  v_dot2c_f32_bf16_dpp v72, v56, v208 row_newbcast:12 row_mask:0xf bank_mask:0xf
  v_dot2c_f32_bf16_dpp v73, v64, v208 row_newbcast:12 row_mask:0xf bank_mask:0xf
  v_dot2c_f32_bf16_dpp v74, v56, v209 row_newbcast:12 row_mask:0xf bank_mask:0xf
  v_dot2c_f32_bf16_dpp v75, v64, v209 row_newbcast:12 row_mask:0xf bank_mask:0xf
  v_dot2c_f32_bf16_dpp v76, v56, v210 row_newbcast:12 row_mask:0xf bank_mask:0xf
  v_dot2c_f32_bf16_dpp v77, v64, v210 row_newbcast:12 row_mask:0xf bank_mask:0xf
  v_dot2c_f32_bf16_dpp v78, v56, v211 row_newbcast:12 row_mask:0xf bank_mask:0xf
  v_dot2c_f32_bf16_dpp v79, v64, v211 row_newbcast:12 row_mask:0xf bank_mask:0xf
  s_waitcnt vmcnt(2)
  s_mov_b32 s42, 131072
  buffer_load_dwordx4 v[160:163], v2, s[8:11], s42 offen offset:0 nt
  s_or_b32 s43, s3, s101
  s_cbranch_scc1 L_v1s
  v_xor_b32 v227, v227, v123
  v_readlane_b32 s43, v226, 0
  s_nop 1
  v_bitop3_b32 v227, v227, v80, s43 bitop3:0xf6
  v_readlane_b32 s43, v226, 1
  s_nop 1
  v_bitop3_b32 v227, v227, v81, s43 bitop3:0xf6
  v_readlane_b32 s43, v226, 2
  s_nop 1
  v_bitop3_b32 v227, v227, v82, s43 bitop3:0xf6
  v_readlane_b32 s43, v226, 3
  s_nop 1
  v_bitop3_b32 v227, v227, v83, s43 bitop3:0xf6
  v_readlane_b32 s43, v226, 4
  s_nop 1
  v_bitop3_b32 v227, v227, v84, s43 bitop3:0xf6
  v_readlane_b32 s43, v226, 5
  s_nop 1
  v_bitop3_b32 v227, v227, v85, s43 bitop3:0xf6
  v_readlane_b32 s43, v226, 6
  s_nop 1
  v_bitop3_b32 v227, v227, v86, s43 bitop3:0xf6
  v_readlane_b32 s43, v226, 7
  s_nop 1
  v_bitop3_b32 v227, v227, v87, s43 bitop3:0xf6
  v_cmp_ne_u32 vcc, 0, v227
  s_cbranch_vccz L_v1s
  v_mov_b32 v228, 1
  ds_write_b32 v33, v228 offset:6244
L_v1s:
  v_dot2c_f32_bf16_dpp v72, v56, v212 row_newbcast:13 row_mask:0xf bank_mask:0xf
  v_dot2c_f32_bf16_dpp v73, v64, v212 row_newbcast:13 row_mask:0xf bank_mask:0xf
  v_dot2c_f32_bf16_dpp v74, v56, v213 row_newbcast:13 row_mask:0xf bank_mask:0xf
  v_dot2c_f32_bf16_dpp v75, v64, v213 row_newbcast:13 row_mask:0xf bank_mask:0xf
  v_dot2c_f32_bf16_dpp v76, v56, v214 row_newbcast:13 row_mask:0xf bank_mask:0xf
  v_dot2c_f32_bf16_dpp v77, v64, v214 row_newbcast:13 row_mask:0xf bank_mask:0xf
  v_dot2c_f32_bf16_dpp v78, v56, v215 row_newbcast:13 row_mask:0xf bank_mask:0xf
  v_dot2c_f32_bf16_dpp v79, v64, v215 row_newbcast:13 row_mask:0xf bank_mask:0xf
  s_waitcnt vmcnt(2)
  s_mov_b32 s42, 139264
  buffer_load_dwordx4 v[164:167], v2, s[8:11], s42 offen offset:0 nt
  s_memrealtime s[94:95]
  ds_read_b32 v31, v33 offset:6208
  v_dot2c_f32_bf16_dpp v72, v56, v216 row_newbcast:14 row_mask:0xf bank_mask:0xf
  v_dot2c_f32_bf16_dpp v73, v64, v216 row_newbcast:14 row_mask:0xf bank_mask:0xf
  v_dot2c_f32_bf16_dpp v74, v56, v217 row_newbcast:14 row_mask:0xf bank_mask:0xf
  v_dot2c_f32_bf16_dpp v75, v64, v217 row_newbcast:14 row_mask:0xf bank_mask:0xf
  v_dot2c_f32_bf16_dpp v76, v56, v218 row_newbcast:14 row_mask:0xf bank_mask:0xf
  v_dot2c_f32_bf16_dpp v77, v64, v218 row_newbcast:14 row_mask:0xf bank_mask:0xf
  v_dot2c_f32_bf16_dpp v78, v56, v219 row_newbcast:14 row_mask:0xf bank_mask:0xf
  v_dot2c_f32_bf16_dpp v79, v64, v219 row_newbcast:14 row_mask:0xf bank_mask:0xf
  s_waitcnt vmcnt(2)
  s_mov_b32 s42, 147456
  buffer_load_dwordx4 v[168:171], v2, s[8:11], s42 offen offset:0 nt
  v_dot2c_f32_bf16_dpp v72, v56, v220 row_newbcast:15 row_mask:0xf bank_mask:0xf
  v_dot2c_f32_bf16_dpp v73, v64, v220 row_newbcast:15 row_mask:0xf bank_mask:0xf
  v_dot2c_f32_bf16_dpp v74, v56, v221 row_newbcast:15 row_mask:0xf bank_mask:0xf
  v_dot2c_f32_bf16_dpp v75, v64, v221 row_newbcast:15 row_mask:0xf bank_mask:0xf
  v_dot2c_f32_bf16_dpp v76, v56, v222 row_newbcast:15 row_mask:0xf bank_mask:0xf
  v_dot2c_f32_bf16_dpp v77, v64, v222 row_newbcast:15 row_mask:0xf bank_mask:0xf
  v_dot2c_f32_bf16_dpp v78, v56, v223 row_newbcast:15 row_mask:0xf bank_mask:0xf
  v_dot2c_f32_bf16_dpp v79, v64, v223 row_newbcast:15 row_mask:0xf bank_mask:0xf
  v_mov_b32 v56, v57
  v_mov_b32 v64, v65
  v_mov_b32 v57, v58
  v_mov_b32 v65, v66
  v_mov_b32 v58, v59
  v_mov_b32 v66, v67
  v_mov_b32 v59, v60
  v_mov_b32 v67, v68
  v_mov_b32 v60, v61
  v_mov_b32 v68, v69
  v_mov_b32 v61, v62
  v_mov_b32 v69, v70
  v_mov_b32 v62, v63
  v_mov_b32 v70, v71
  s_mov_b32 s40, 0
  s_mov_b32 s99, 3
  s_add_u32 s92, s92, 540
  s_waitcnt lgkmcnt(0)
  v_readfirstlane_b32 s63, v31
  s_sub_u32 s93, s94, s92
  s_sub_u32 s43, s63, s93
  s_cmp_eq_u32 s63, 0x80000000
  s_cselect_b32 s43, 0, s43
  s_cselect_b32 s96, s61, 3
  s_cmp_gt_i32 s43, s13
  s_cselect_b32 s96, 2, s96
  s_cmp_lt_i32 s43, s14
  s_cselect_b32 s96, 4, s96
  s_cmp_lt_i32 s43, s15
  s_cselect_b32 s96, 6, s96
L_v0_next:
  s_add_u32 s40, s40, 131072
  s_add_u32 s98, s98, 1
  s_cmp_ge_u32 s40, 1048576
  s_cbranch_scc1 L_v_done
  s_add_u32 s97, s40, 131072
  s_cmp_eq_u32 s40, 917504
  s_cselect_b32 s97, 1048576, s97
  s_cmp_ge_u32 s40, 917504
  s_cselect_b32 s13, 30, s13
  s_cselect_b32 s14, -10, s14
  s_cselect_b32 s15, -30, s15
  s_cmp_gt_u32 s99, 2
  s_cbranch_scc1 L_v0_u2
  s_cmp_le_u32 s96, 2
  s_cbranch_scc1 L_v0_u2
  s_add_u32 s42, s40, 16384
  buffer_load_dwordx4 v[168:171], v2, s[8:11], s42 offen offset:0 nt
L_v0_u2:
  s_cmp_gt_u32 s99, 3
  s_cbranch_scc1 L_v0_u3
  s_cmp_le_u32 s96, 3
  s_cbranch_scc1 L_v0_u3
  s_add_u32 s42, s40, 24576
  buffer_load_dwordx4 v[172:175], v2, s[8:11], s42 offen offset:0 nt
L_v0_u3:
  s_cmp_gt_u32 s99, 4
  s_cbranch_scc1 L_v0_u4
  s_cmp_le_u32 s96, 4
  s_cbranch_scc1 L_v0_u4
  s_add_u32 s42, s40, 32768
  buffer_load_dwordx4 v[176:179], v2, s[8:11], s42 offen offset:0 nt
L_v0_u4:
  s_cmp_gt_u32 s99, 5
  s_cbranch_scc1 L_v0_u5
  s_cmp_le_u32 s96, 5
  s_cbranch_scc1 L_v0_u5
  s_add_u32 s42, s40, 40960
  buffer_load_dwordx4 v[180:183], v2, s[8:11], s42 offen offset:0 nt
L_v0_u5:
  s_cmp_eq_u32 s96, 3
  s_cbranch_scc1 L_v0_b3
  s_cmp_eq_u32 s96, 4
  s_cbranch_scc1 L_v0_b4
  s_cmp_eq_u32 s96, 6
  s_cbranch_scc1 L_v0_b6
L_v0_b2:
  s_waitcnt vmcnt(1)
  s_cmp_gt_u32 s99, 2
  s_cbranch_scc1 L_v0_b2s2
  s_add_u32 s42, s40, 16384
  buffer_load_dwordx4 v[168:171], v2, s[8:11], s42 offen offset:0 nt
L_v0_b2s2:
  s_lshl_b32 s47, s90, 10
  s_add_u32 s43, s47, s91
  s_mul_i32 s47, s90, s46
  s_bitcmp1_b32 s37, s98
  s_cselect_b32 m0, s43, s36
  s_cselect_b32 s22, s60, 0
  s_cselect_b32 s43, 1, 0
  buffer_load_dwordx4 v39, s[20:23], s47 offen  lds
  s_add_u32 s90, s90, s43
  s_and_b32 s43, s98, 7
  s_cmp_lg_u32 s43, s3
  s_cbranch_scc1 L_c0_13
  v_mov_b32 v32, s93
  s_mov_b32 s62, s93
  s_mul_i32 s47, s98, 8192
  buffer_store_dword v32, v36, s[24:27], s47 offen sc1
  s_lshr_b32 s43, s2, 3
  s_mul_i32 s47, s98, 5
  s_add_u32 s43, s43, s47
  s_and_b32 s43, s43, 3
  s_mul_i32 s43, s43, 2048
  s_add_u32 s43, s43, 1048576
  s_sub_u32 s47, s98, 1
  s_max_i32 s47, s47, 0
  s_mul_i32 s47, s47, 8192
  s_add_u32 s43, s43, s47
  buffer_load_dword v34, v35, s[24:27], s43 offen
L_c0_13:
  v_dot2c_f32_bf16_dpp v72, v56, v160 row_newbcast:0 row_mask:0xf bank_mask:0xf
  v_dot2c_f32_bf16_dpp v73, v64, v160 row_newbcast:0 row_mask:0xf bank_mask:0xf
  v_dot2c_f32_bf16_dpp v74, v56, v161 row_newbcast:0 row_mask:0xf bank_mask:0xf
  v_dot2c_f32_bf16_dpp v75, v64, v161 row_newbcast:0 row_mask:0xf bank_mask:0xf
  v_dot2c_f32_bf16_dpp v76, v56, v162 row_newbcast:0 row_mask:0xf bank_mask:0xf
  v_dot2c_f32_bf16_dpp v77, v64, v162 row_newbcast:0 row_mask:0xf bank_mask:0xf
  v_dot2c_f32_bf16_dpp v78, v56, v163 row_newbcast:0 row_mask:0xf bank_mask:0xf
  v_dot2c_f32_bf16_dpp v79, v64, v163 row_newbcast:0 row_mask:0xf bank_mask:0xf
  s_waitcnt vmcnt(2)
  s_cmp_gt_u32 s99, 3
  s_cbranch_scc1 L_v0_b2s3
  s_add_u32 s42, s40, 24576
  buffer_load_dwordx4 v[172:175], v2, s[8:11], s42 offen offset:0 nt
L_v0_b2s3:
  v_dot2c_f32_bf16_dpp v72, v56, v164 row_newbcast:1 row_mask:0xf bank_mask:0xf
  v_dot2c_f32_bf16_dpp v73, v64, v164 row_newbcast:1 row_mask:0xf bank_mask:0xf
  v_dot2c_f32_bf16_dpp v74, v56, v165 row_newbcast:1 row_mask:0xf bank_mask:0xf
  v_dot2c_f32_bf16_dpp v75, v64, v165 row_newbcast:1 row_mask:0xf bank_mask:0xf
  v_dot2c_f32_bf16_dpp v76, v56, v166 row_newbcast:1 row_mask:0xf bank_mask:0xf
  v_dot2c_f32_bf16_dpp v77, v64, v166 row_newbcast:1 row_mask:0xf bank_mask:0xf
  v_dot2c_f32_bf16_dpp v78, v56, v167 row_newbcast:1 row_mask:0xf bank_mask:0xf
  v_dot2c_f32_bf16_dpp v79, v64, v167 row_newbcast:1 row_mask:0xf bank_mask:0xf
  s_waitcnt vmcnt(2)
  s_cmp_gt_u32 s99, 4
  s_cbranch_scc1 L_v0_b2s4
  s_add_u32 s42, s40, 32768
  buffer_load_dwordx4 v[176:179], v2, s[8:11], s42 offen offset:0 nt
L_v0_b2s4:
  s_memrealtime s[94:95]
  ds_read_b32 v31, v33 offset:6208
  v_dot2c_f32_bf16_dpp v72, v56, v168 row_newbcast:2 row_mask:0xf bank_mask:0xf
  v_dot2c_f32_bf16_dpp v73, v64, v168 row_newbcast:2 row_mask:0xf bank_mask:0xf
  v_dot2c_f32_bf16_dpp v74, v56, v169 row_newbcast:2 row_mask:0xf bank_mask:0xf
  v_dot2c_f32_bf16_dpp v75, v64, v169 row_newbcast:2 row_mask:0xf bank_mask:0xf
  v_dot2c_f32_bf16_dpp v76, v56, v170 row_newbcast:2 row_mask:0xf bank_mask:0xf
  v_dot2c_f32_bf16_dpp v77, v64, v170 row_newbcast:2 row_mask:0xf bank_mask:0xf
  v_dot2c_f32_bf16_dpp v78, v56, v171 row_newbcast:2 row_mask:0xf bank_mask:0xf
  v_dot2c_f32_bf16_dpp v79, v64, v171 row_newbcast:2 row_mask:0xf bank_mask:0xf
  s_waitcnt vmcnt(1)
  s_cmp_gt_u32 s99, 5
  s_cbranch_scc1 L_v0_b2s5
  s_add_u32 s42, s40, 40960
  buffer_load_dwordx4 v[180:183], v2, s[8:11], s42 offen offset:0 nt
L_v0_b2s5:
  v_dot2c_f32_bf16_dpp v72, v56, v172 row_newbcast:3 row_mask:0xf bank_mask:0xf
  v_dot2c_f32_bf16_dpp v73, v64, v172 row_newbcast:3 row_mask:0xf bank_mask:0xf
  v_dot2c_f32_bf16_dpp v74, v56, v173 row_newbcast:3 row_mask:0xf bank_mask:0xf
  v_dot2c_f32_bf16_dpp v75, v64, v173 row_newbcast:3 row_mask:0xf bank_mask:0xf
  v_dot2c_f32_bf16_dpp v76, v56, v174 row_newbcast:3 row_mask:0xf bank_mask:0xf
  v_dot2c_f32_bf16_dpp v77, v64, v174 row_newbcast:3 row_mask:0xf bank_mask:0xf
  v_dot2c_f32_bf16_dpp v78, v56, v175 row_newbcast:3 row_mask:0xf bank_mask:0xf
  v_dot2c_f32_bf16_dpp v79, v64, v175 row_newbcast:3 row_mask:0xf bank_mask:0xf
  s_add_u32 s92, s92, 110
  s_waitcnt lgkmcnt(0)
  v_readfirstlane_b32 s63, v31
  s_sub_u32 s93, s94, s92
  s_sub_u32 s43, s63, s93
  s_cmp_eq_u32 s63, 0x80000000
  s_cselect_b32 s43, 0, s43
  s_cselect_b32 s96, s61, 3
  s_cmp_gt_i32 s43, s13
  s_cselect_b32 s96, 2, s96
  s_cmp_lt_i32 s43, s14
  s_cselect_b32 s96, 4, s96
  s_cmp_lt_i32 s43, s15
  s_cselect_b32 s96, 6, s96
  s_mov_b32 s99, 2
  s_branch L_v1_next
L_v0_b3:
  s_waitcnt vmcnt(2)
  s_cmp_gt_u32 s99, 3
  s_cbranch_scc1 L_v0_b3s3
  s_add_u32 s42, s40, 24576
  buffer_load_dwordx4 v[172:175], v2, s[8:11], s42 offen offset:0 nt
L_v0_b3s3:
  s_lshl_b32 s47, s90, 10
  s_add_u32 s43, s47, s91
  s_mul_i32 s47, s90, s46
  s_bitcmp1_b32 s37, s98
  s_cselect_b32 m0, s43, s36
  s_cselect_b32 s22, s60, 0
  s_cselect_b32 s43, 1, 0
  buffer_load_dwordx4 v39, s[20:23], s47 offen  lds
  s_add_u32 s90, s90, s43
  s_and_b32 s43, s98, 7
  s_cmp_lg_u32 s43, s3
  s_cbranch_scc1 L_c0_14
  v_mov_b32 v32, s93
  s_mov_b32 s62, s93
  s_mul_i32 s47, s98, 8192
  buffer_store_dword v32, v36, s[24:27], s47 offen sc1
  s_lshr_b32 s43, s2, 3
  s_mul_i32 s47, s98, 5
  s_add_u32 s43, s43, s47
  s_and_b32 s43, s43, 3
  s_mul_i32 s43, s43, 2048
  s_add_u32 s43, s43, 1048576
  s_sub_u32 s47, s98, 1
  s_max_i32 s47, s47, 0
  s_mul_i32 s47, s47, 8192
  s_add_u32 s43, s43, s47
  buffer_load_dword v34, v35, s[24:27], s43 offen
L_c0_14:
  v_dot2c_f32_bf16_dpp v72, v56, v160 row_newbcast:0 row_mask:0xf bank_mask:0xf
  v_dot2c_f32_bf16_dpp v73, v64, v160 row_newbcast:0 row_mask:0xf bank_mask:0xf
  v_dot2c_f32_bf16_dpp v74, v56, v161 row_newbcast:0 row_mask:0xf bank_mask:0xf
  v_dot2c_f32_bf16_dpp v75, v64, v161 row_newbcast:0 row_mask:0xf bank_mask:0xf
  v_dot2c_f32_bf16_dpp v76, v56, v162 row_newbcast:0 row_mask:0xf bank_mask:0xf
  v_dot2c_f32_bf16_dpp v77, v64, v162 row_newbcast:0 row_mask:0xf bank_mask:0xf
  v_dot2c_f32_bf16_dpp v78, v56, v163 row_newbcast:0 row_mask:0xf bank_mask:0xf
  v_dot2c_f32_bf16_dpp v79, v64, v163 row_newbcast:0 row_mask:0xf bank_mask:0xf
  s_waitcnt vmcnt(3)
  s_cmp_gt_u32 s99, 4
  s_cbranch_scc1 L_v0_b3s4
  s_add_u32 s42, s40, 32768
  buffer_load_dwordx4 v[176:179], v2, s[8:11], s42 offen offset:0 nt
L_v0_b3s4:
  v_dot2c_f32_bf16_dpp v72, v56, v164 row_newbcast:1 row_mask:0xf bank_mask:0xf
  v_dot2c_f32_bf16_dpp v73, v64, v164 row_newbcast:1 row_mask:0xf bank_mask:0xf
  v_dot2c_f32_bf16_dpp v74, v56, v165 row_newbcast:1 row_mask:0xf bank_mask:0xf
  v_dot2c_f32_bf16_dpp v75, v64, v165 row_newbcast:1 row_mask:0xf bank_mask:0xf
  v_dot2c_f32_bf16_dpp v76, v56, v166 row_newbcast:1 row_mask:0xf bank_mask:0xf
  v_dot2c_f32_bf16_dpp v77, v64, v166 row_newbcast:1 row_mask:0xf bank_mask:0xf
  v_dot2c_f32_bf16_dpp v78, v56, v167 row_newbcast:1 row_mask:0xf bank_mask:0xf
  v_dot2c_f32_bf16_dpp v79, v64, v167 row_newbcast:1 row_mask:0xf bank_mask:0xf
  s_waitcnt vmcnt(3)
  s_cmp_gt_u32 s99, 5
  s_cbranch_scc1 L_v0_b3s5
  s_add_u32 s42, s40, 40960
  buffer_load_dwordx4 v[180:183], v2, s[8:11], s42 offen offset:0 nt
L_v0_b3s5:
  s_memrealtime s[94:95]
  ds_read_b32 v31, v33 offset:6208
  v_dot2c_f32_bf16_dpp v72, v56, v168 row_newbcast:2 row_mask:0xf bank_mask:0xf
  v_dot2c_f32_bf16_dpp v73, v64, v168 row_newbcast:2 row_mask:0xf bank_mask:0xf
  v_dot2c_f32_bf16_dpp v74, v56, v169 row_newbcast:2 row_mask:0xf bank_mask:0xf
  v_dot2c_f32_bf16_dpp v75, v64, v169 row_newbcast:2 row_mask:0xf bank_mask:0xf
  v_dot2c_f32_bf16_dpp v76, v56, v170 row_newbcast:2 row_mask:0xf bank_mask:0xf
  v_dot2c_f32_bf16_dpp v77, v64, v170 row_newbcast:2 row_mask:0xf bank_mask:0xf
  v_dot2c_f32_bf16_dpp v78, v56, v171 row_newbcast:2 row_mask:0xf bank_mask:0xf
  v_dot2c_f32_bf16_dpp v79, v64, v171 row_newbcast:2 row_mask:0xf bank_mask:0xf
  s_waitcnt vmcnt(3)
  s_add_u32 s42, s40, 49152
  buffer_load_dwordx4 v[184:187], v2, s[8:11], s42 offen offset:0 nt
  v_dot2c_f32_bf16_dpp v72, v56, v172 row_newbcast:3 row_mask:0xf bank_mask:0xf
  v_dot2c_f32_bf16_dpp v73, v64, v172 row_newbcast:3 row_mask:0xf bank_mask:0xf
  v_dot2c_f32_bf16_dpp v74, v56, v173 row_newbcast:3 row_mask:0xf bank_mask:0xf
  v_dot2c_f32_bf16_dpp v75, v64, v173 row_newbcast:3 row_mask:0xf bank_mask:0xf
  v_dot2c_f32_bf16_dpp v76, v56, v174 row_newbcast:3 row_mask:0xf bank_mask:0xf
  v_dot2c_f32_bf16_dpp v77, v64, v174 row_newbcast:3 row_mask:0xf bank_mask:0xf
  v_dot2c_f32_bf16_dpp v78, v56, v175 row_newbcast:3 row_mask:0xf bank_mask:0xf
  v_dot2c_f32_bf16_dpp v79, v64, v175 row_newbcast:3 row_mask:0xf bank_mask:0xf
  s_add_u32 s92, s92, 110
  s_waitcnt lgkmcnt(0)
  v_readfirstlane_b32 s63, v31
  s_sub_u32 s93, s94, s92
  s_sub_u32 s43, s63, s93
  s_cmp_eq_u32 s63, 0x80000000
  s_cselect_b32 s43, 0, s43
  s_cselect_b32 s96, s61, 3
  s_cmp_gt_i32 s43, s13
  s_cselect_b32 s96, 2, s96
  s_cmp_lt_i32 s43, s14
  s_cselect_b32 s96, 4, s96
  s_cmp_lt_i32 s43, s15
  s_cselect_b32 s96, 6, s96
  s_mov_b32 s99, 3
  s_branch L_v1_next
L_v0_b4:
  s_waitcnt vmcnt(3)
  s_cmp_gt_u32 s99, 4
  s_cbranch_scc1 L_v0_b4s4
  s_add_u32 s42, s40, 32768
  buffer_load_dwordx4 v[176:179], v2, s[8:11], s42 offen offset:0 nt
L_v0_b4s4:
  s_lshl_b32 s47, s90, 10
  s_add_u32 s43, s47, s91
  s_mul_i32 s47, s90, s46
  s_bitcmp1_b32 s37, s98
  s_cselect_b32 m0, s43, s36
  s_cselect_b32 s22, s60, 0
  s_cselect_b32 s43, 1, 0
  buffer_load_dwordx4 v39, s[20:23], s47 offen  lds
  s_add_u32 s90, s90, s43
  s_and_b32 s43, s98, 7
  s_cmp_lg_u32 s43, s3
  s_cbranch_scc1 L_c0_15
  v_mov_b32 v32, s93
  s_mov_b32 s62, s93
  s_mul_i32 s47, s98, 8192
  buffer_store_dword v32, v36, s[24:27], s47 offen sc1
  s_lshr_b32 s43, s2, 3
  s_mul_i32 s47, s98, 5
  s_add_u32 s43, s43, s47
  s_and_b32 s43, s43, 3
  s_mul_i32 s43, s43, 2048
  s_add_u32 s43, s43, 1048576
  s_sub_u32 s47, s98, 1
  s_max_i32 s47, s47, 0
  s_mul_i32 s47, s47, 8192
  s_add_u32 s43, s43, s47
  buffer_load_dword v34, v35, s[24:27], s43 offen
L_c0_15:
  v_dot2c_f32_bf16_dpp v72, v56, v160 row_newbcast:0 row_mask:0xf bank_mask:0xf
  v_dot2c_f32_bf16_dpp v73, v64, v160 row_newbcast:0 row_mask:0xf bank_mask:0xf
  v_dot2c_f32_bf16_dpp v74, v56, v161 row_newbcast:0 row_mask:0xf bank_mask:0xf
  v_dot2c_f32_bf16_dpp v75, v64, v161 row_newbcast:0 row_mask:0xf bank_mask:0xf
  v_dot2c_f32_bf16_dpp v76, v56, v162 row_newbcast:0 row_mask:0xf bank_mask:0xf
  v_dot2c_f32_bf16_dpp v77, v64, v162 row_newbcast:0 row_mask:0xf bank_mask:0xf
  v_dot2c_f32_bf16_dpp v78, v56, v163 row_newbcast:0 row_mask:0xf bank_mask:0xf
  v_dot2c_f32_bf16_dpp v79, v64, v163 row_newbcast:0 row_mask:0xf bank_mask:0xf
  s_waitcnt vmcnt(4)
  s_cmp_gt_u32 s99, 5
  s_cbranch_scc1 L_v0_b4s5
  s_add_u32 s42, s40, 40960
  buffer_load_dwordx4 v[180:183], v2, s[8:11], s42 offen offset:0 nt
L_v0_b4s5:
  v_dot2c_f32_bf16_dpp v72, v56, v164 row_newbcast:1 row_mask:0xf bank_mask:0xf
  v_dot2c_f32_bf16_dpp v73, v64, v164 row_newbcast:1 row_mask:0xf bank_mask:0xf
  v_dot2c_f32_bf16_dpp v74, v56, v165 row_newbcast:1 row_mask:0xf bank_mask:0xf
  v_dot2c_f32_bf16_dpp v75, v64, v165 row_newbcast:1 row_mask:0xf bank_mask:0xf
  v_dot2c_f32_bf16_dpp v76, v56, v166 row_newbcast:1 row_mask:0xf bank_mask:0xf
  v_dot2c_f32_bf16_dpp v77, v64, v166 row_newbcast:1 row_mask:0xf bank_mask:0xf
  v_dot2c_f32_bf16_dpp v78, v56, v167 row_newbcast:1 row_mask:0xf bank_mask:0xf
  v_dot2c_f32_bf16_dpp v79, v64, v167 row_newbcast:1 row_mask:0xf bank_mask:0xf
  s_waitcnt vmcnt(4)
  s_add_u32 s42, s40, 49152
  buffer_load_dwordx4 v[184:187], v2, s[8:11], s42 offen offset:0 nt
  s_memrealtime s[94:95]
  ds_read_b32 v31, v33 offset:6208
  v_dot2c_f32_bf16_dpp v72, v56, v168 row_newbcast:2 row_mask:0xf bank_mask:0xf
  v_dot2c_f32_bf16_dpp v73, v64, v168 row_newbcast:2 row_mask:0xf bank_mask:0xf
  v_dot2c_f32_bf16_dpp v74, v56, v169 row_newbcast:2 row_mask:0xf bank_mask:0xf
  v_dot2c_f32_bf16_dpp v75, v64, v169 row_newbcast:2 row_mask:0xf bank_mask:0xf
  v_dot2c_f32_bf16_dpp v76, v56, v170 row_newbcast:2 row_mask:0xf bank_mask:0xf
  v_dot2c_f32_bf16_dpp v77, v64, v170 row_newbcast:2 row_mask:0xf bank_mask:0xf
  v_dot2c_f32_bf16_dpp v78, v56, v171 row_newbcast:2 row_mask:0xf bank_mask:0xf
  v_dot2c_f32_bf16_dpp v79, v64, v171 row_newbcast:2 row_mask:0xf bank_mask:0xf
  s_waitcnt vmcnt(4)
  s_add_u32 s42, s40, 57344
  buffer_load_dwordx4 v[188:191], v2, s[8:11], s42 offen offset:0 nt
  v_dot2c_f32_bf16_dpp v72, v56, v172 row_newbcast:3 row_mask:0xf bank_mask:0xf
  v_dot2c_f32_bf16_dpp v73, v64, v172 row_newbcast:3 row_mask:0xf bank_mask:0xf
  v_dot2c_f32_bf16_dpp v74, v56, v173 row_newbcast:3 row_mask:0xf bank_mask:0xf
  v_dot2c_f32_bf16_dpp v75, v64, v173 row_newbcast:3 row_mask:0xf bank_mask:0xf
  v_dot2c_f32_bf16_dpp v76, v56, v174 row_newbcast:3 row_mask:0xf bank_mask:0xf
  v_dot2c_f32_bf16_dpp v77, v64, v174 row_newbcast:3 row_mask:0xf bank_mask:0xf
  v_dot2c_f32_bf16_dpp v78, v56, v175 row_newbcast:3 row_mask:0xf bank_mask:0xf
  v_dot2c_f32_bf16_dpp v79, v64, v175 row_newbcast:3 row_mask:0xf bank_mask:0xf
  s_add_u32 s92, s92, 110
  s_waitcnt lgkmcnt(0)
  v_readfirstlane_b32 s63, v31
  s_sub_u32 s93, s94, s92
  s_sub_u32 s43, s63, s93
  s_cmp_eq_u32 s63, 0x80000000
  s_cselect_b32 s43, 0, s43
  s_cselect_b32 s96, s61, 3
  s_cmp_gt_i32 s43, s13
  s_cselect_b32 s96, 2, s96
  s_cmp_lt_i32 s43, s14
  s_cselect_b32 s96, 4, s96
  s_cmp_lt_i32 s43, s15
  s_cselect_b32 s96, 6, s96
  s_mov_b32 s99, 4
  s_branch L_v1_next
L_v0_b6:
  s_waitcnt vmcnt(5)
  s_add_u32 s42, s40, 49152
  buffer_load_dwordx4 v[184:187], v2, s[8:11], s42 offen offset:0 nt
  s_lshl_b32 s47, s90, 10
  s_add_u32 s43, s47, s91
  s_mul_i32 s47, s90, s46
  s_bitcmp1_b32 s37, s98
  s_cselect_b32 m0, s43, s36
  s_cselect_b32 s22, s60, 0
  s_cselect_b32 s43, 1, 0
  buffer_load_dwordx4 v39, s[20:23], s47 offen  lds
  s_add_u32 s90, s90, s43
  s_and_b32 s43, s98, 7
  s_cmp_lg_u32 s43, s3
  s_cbranch_scc1 L_c0_16
  v_mov_b32 v32, s93
  s_mov_b32 s62, s93
  s_mul_i32 s47, s98, 8192
  buffer_store_dword v32, v36, s[24:27], s47 offen sc1
  s_lshr_b32 s43, s2, 3
  s_mul_i32 s47, s98, 5
  s_add_u32 s43, s43, s47
  s_and_b32 s43, s43, 3
  s_mul_i32 s43, s43, 2048
  s_add_u32 s43, s43, 1048576
  s_sub_u32 s47, s98, 1
  s_max_i32 s47, s47, 0
  s_mul_i32 s47, s47, 8192
  s_add_u32 s43, s43, s47
  buffer_load_dword v34, v35, s[24:27], s43 offen
L_c0_16:
  v_dot2c_f32_bf16_dpp v72, v56, v160 row_newbcast:0 row_mask:0xf bank_mask:0xf
  v_dot2c_f32_bf16_dpp v73, v64, v160 row_newbcast:0 row_mask:0xf bank_mask:0xf
  v_dot2c_f32_bf16_dpp v74, v56, v161 row_newbcast:0 row_mask:0xf bank_mask:0xf
  v_dot2c_f32_bf16_dpp v75, v64, v161 row_newbcast:0 row_mask:0xf bank_mask:0xf
  v_dot2c_f32_bf16_dpp v76, v56, v162 row_newbcast:0 row_mask:0xf bank_mask:0xf
  v_dot2c_f32_bf16_dpp v77, v64, v162 row_newbcast:0 row_mask:0xf bank_mask:0xf
  v_dot2c_f32_bf16_dpp v78, v56, v163 row_newbcast:0 row_mask:0xf bank_mask:0xf
  v_dot2c_f32_bf16_dpp v79, v64, v163 row_newbcast:0 row_mask:0xf bank_mask:0xf
  s_waitcnt vmcnt(6)
  s_add_u32 s42, s40, 57344
  buffer_load_dwordx4 v[188:191], v2, s[8:11], s42 offen offset:0 nt
  v_dot2c_f32_bf16_dpp v72, v56, v164 row_newbcast:1 row_mask:0xf bank_mask:0xf
  v_dot2c_f32_bf16_dpp v73, v64, v164 row_newbcast:1 row_mask:0xf bank_mask:0xf
  v_dot2c_f32_bf16_dpp v74, v56, v165 row_newbcast:1 row_mask:0xf bank_mask:0xf
  v_dot2c_f32_bf16_dpp v75, v64, v165 row_newbcast:1 row_mask:0xf bank_mask:0xf
  v_dot2c_f32_bf16_dpp v76, v56, v166 row_newbcast:1 row_mask:0xf bank_mask:0xf
  v_dot2c_f32_bf16_dpp v77, v64, v166 row_newbcast:1 row_mask:0xf bank_mask:0xf
  v_dot2c_f32_bf16_dpp v78, v56, v167 row_newbcast:1 row_mask:0xf bank_mask:0xf
  v_dot2c_f32_bf16_dpp v79, v64, v167 row_newbcast:1 row_mask:0xf bank_mask:0xf
  s_waitcnt vmcnt(6)
  s_add_u32 s42, s40, 65536
  buffer_load_dwordx4 v[192:195], v2, s[8:11], s42 offen offset:0 nt
  s_memrealtime s[94:95]
  ds_read_b32 v31, v33 offset:6208
  v_dot2c_f32_bf16_dpp v72, v56, v168 row_newbcast:2 row_mask:0xf bank_mask:0xf
  v_dot2c_f32_bf16_dpp v73, v64, v168 row_newbcast:2 row_mask:0xf bank_mask:0xf
  v_dot2c_f32_bf16_dpp v74, v56, v169 row_newbcast:2 row_mask:0xf bank_mask:0xf
  v_dot2c_f32_bf16_dpp v75, v64, v169 row_newbcast:2 row_mask:0xf bank_mask:0xf
  v_dot2c_f32_bf16_dpp v76, v56, v170 row_newbcast:2 row_mask:0xf bank_mask:0xf
  v_dot2c_f32_bf16_dpp v77, v64, v170 row_newbcast:2 row_mask:0xf bank_mask:0xf
  v_dot2c_f32_bf16_dpp v78, v56, v171 row_newbcast:2 row_mask:0xf bank_mask:0xf
  v_dot2c_f32_bf16_dpp v79, v64, v171 row_newbcast:2 row_mask:0xf bank_mask:0xf
  s_waitcnt vmcnt(6)
  s_add_u32 s42, s40, 73728
  buffer_load_dwordx4 v[196:199], v2, s[8:11], s42 offen offset:0 nt
  v_dot2c_f32_bf16_dpp v72, v56, v172 row_newbcast:3 row_mask:0xf bank_mask:0xf
  v_dot2c_f32_bf16_dpp v73, v64, v172 row_newbcast:3 row_mask:0xf bank_mask:0xf
  v_dot2c_f32_bf16_dpp v74, v56, v173 row_newbcast:3 row_mask:0xf bank_mask:0xf
  v_dot2c_f32_bf16_dpp v75, v64, v173 row_newbcast:3 row_mask:0xf bank_mask:0xf
  v_dot2c_f32_bf16_dpp v76, v56, v174 row_newbcast:3 row_mask:0xf bank_mask:0xf
  v_dot2c_f32_bf16_dpp v77, v64, v174 row_newbcast:3 row_mask:0xf bank_mask:0xf
  v_dot2c_f32_bf16_dpp v78, v56, v175 row_newbcast:3 row_mask:0xf bank_mask:0xf
  v_dot2c_f32_bf16_dpp v79, v64, v175 row_newbcast:3 row_mask:0xf bank_mask:0xf
  s_add_u32 s92, s92, 110
  s_waitcnt lgkmcnt(0)
  v_readfirstlane_b32 s63, v31
  s_sub_u32 s93, s94, s92
  s_sub_u32 s43, s63, s93
  s_cmp_eq_u32 s63, 0x80000000
  s_cselect_b32 s43, 0, s43
  s_cselect_b32 s96, s61, 3
  s_cmp_gt_i32 s43, s13
  s_cselect_b32 s96, 2, s96
  s_cmp_lt_i32 s43, s14
  s_cselect_b32 s96, 4, s96
  s_cmp_lt_i32 s43, s15
  s_cselect_b32 s96, 6, s96
  s_mov_b32 s99, 6
  s_branch L_v1_next
L_v1_next:
  s_cmp_gt_u32 s99, 2
  s_cbranch_scc1 L_v1_u2
  s_cmp_le_u32 s96, 2
  s_cbranch_scc1 L_v1_u2
  s_add_u32 s42, s40, 49152
  buffer_load_dwordx4 v[184:187], v2, s[8:11], s42 offen offset:0 nt
L_v1_u2:
  s_cmp_gt_u32 s99, 3
  s_cbranch_scc1 L_v1_u3
  s_cmp_le_u32 s96, 3
  s_cbranch_scc1 L_v1_u3
  s_add_u32 s42, s40, 57344
  buffer_load_dwordx4 v[188:191], v2, s[8:11], s42 offen offset:0 nt
L_v1_u3:
  s_cmp_gt_u32 s99, 4
  s_cbranch_scc1 L_v1_u4
  s_cmp_le_u32 s96, 4
  s_cbranch_scc1 L_v1_u4
  s_add_u32 s42, s40, 65536
  buffer_load_dwordx4 v[192:195], v2, s[8:11], s42 offen offset:0 nt
L_v1_u4:
  s_cmp_gt_u32 s99, 5
  s_cbranch_scc1 L_v1_u5
  s_cmp_le_u32 s96, 5
  s_cbranch_scc1 L_v1_u5
  s_add_u32 s42, s40, 73728
  buffer_load_dwordx4 v[196:199], v2, s[8:11], s42 offen offset:0 nt
L_v1_u5:
  s_cmp_eq_u32 s96, 3
  s_cbranch_scc1 L_v1_b3
  s_cmp_eq_u32 s96, 4
  s_cbranch_scc1 L_v1_b4
  s_cmp_eq_u32 s96, 6
  s_cbranch_scc1 L_v1_b6
L_v1_b2:
  s_waitcnt vmcnt(1)
  s_cmp_gt_u32 s99, 2
  s_cbranch_scc1 L_v1_b2s2
  s_add_u32 s42, s40, 49152
  buffer_load_dwordx4 v[184:187], v2, s[8:11], s42 offen offset:0 nt
L_v1_b2s2:
  v_dot2c_f32_bf16_dpp v72, v56, v176 row_newbcast:4 row_mask:0xf bank_mask:0xf
  v_dot2c_f32_bf16_dpp v73, v64, v176 row_newbcast:4 row_mask:0xf bank_mask:0xf
  v_dot2c_f32_bf16_dpp v74, v56, v177 row_newbcast:4 row_mask:0xf bank_mask:0xf
  v_dot2c_f32_bf16_dpp v75, v64, v177 row_newbcast:4 row_mask:0xf bank_mask:0xf
  v_dot2c_f32_bf16_dpp v76, v56, v178 row_newbcast:4 row_mask:0xf bank_mask:0xf
  v_dot2c_f32_bf16_dpp v77, v64, v178 row_newbcast:4 row_mask:0xf bank_mask:0xf
  v_dot2c_f32_bf16_dpp v78, v56, v179 row_newbcast:4 row_mask:0xf bank_mask:0xf
  v_dot2c_f32_bf16_dpp v79, v64, v179 row_newbcast:4 row_mask:0xf bank_mask:0xf
  s_waitcnt vmcnt(1)
  s_cmp_gt_u32 s99, 3
  s_cbranch_scc1 L_v1_b2s3
  s_add_u32 s42, s40, 57344
  buffer_load_dwordx4 v[188:191], v2, s[8:11], s42 offen offset:0 nt
L_v1_b2s3:
  v_dot2c_f32_bf16_dpp v72, v56, v180 row_newbcast:5 row_mask:0xf bank_mask:0xf
  v_dot2c_f32_bf16_dpp v73, v64, v180 row_newbcast:5 row_mask:0xf bank_mask:0xf
  v_dot2c_f32_bf16_dpp v74, v56, v181 row_newbcast:5 row_mask:0xf bank_mask:0xf
  v_dot2c_f32_bf16_dpp v75, v64, v181 row_newbcast:5 row_mask:0xf bank_mask:0xf
  v_dot2c_f32_bf16_dpp v76, v56, v182 row_newbcast:5 row_mask:0xf bank_mask:0xf
  v_dot2c_f32_bf16_dpp v77, v64, v182 row_newbcast:5 row_mask:0xf bank_mask:0xf
  v_dot2c_f32_bf16_dpp v78, v56, v183 row_newbcast:5 row_mask:0xf bank_mask:0xf
  v_dot2c_f32_bf16_dpp v79, v64, v183 row_newbcast:5 row_mask:0xf bank_mask:0xf
  s_waitcnt vmcnt(1)
  s_cmp_gt_u32 s99, 4
  s_cbranch_scc1 L_v1_b2s4
  s_add_u32 s42, s40, 65536
  buffer_load_dwordx4 v[192:195], v2, s[8:11], s42 offen offset:0 nt
L_v1_b2s4:
  s_memrealtime s[94:95]
  ds_read_b32 v31, v33 offset:6208
  v_dot2c_f32_bf16_dpp v72, v56, v184 row_newbcast:6 row_mask:0xf bank_mask:0xf
  v_dot2c_f32_bf16_dpp v73, v64, v184 row_newbcast:6 row_mask:0xf bank_mask:0xf
  v_dot2c_f32_bf16_dpp v74, v56, v185 row_newbcast:6 row_mask:0xf bank_mask:0xf
  v_dot2c_f32_bf16_dpp v75, v64, v185 row_newbcast:6 row_mask:0xf bank_mask:0xf
  v_dot2c_f32_bf16_dpp v76, v56, v186 row_newbcast:6 row_mask:0xf bank_mask:0xf
  v_dot2c_f32_bf16_dpp v77, v64, v186 row_newbcast:6 row_mask:0xf bank_mask:0xf
  v_dot2c_f32_bf16_dpp v78, v56, v187 row_newbcast:6 row_mask:0xf bank_mask:0xf
  v_dot2c_f32_bf16_dpp v79, v64, v187 row_newbcast:6 row_mask:0xf bank_mask:0xf
  s_waitcnt vmcnt(1)
  s_cmp_gt_u32 s99, 5
  s_cbranch_scc1 L_v1_b2s5
  s_add_u32 s42, s40, 73728
  buffer_load_dwordx4 v[196:199], v2, s[8:11], s42 offen offset:0 nt
L_v1_b2s5:
  v_dot2c_f32_bf16_dpp v72, v56, v188 row_newbcast:7 row_mask:0xf bank_mask:0xf
  v_dot2c_f32_bf16_dpp v73, v64, v188 row_newbcast:7 row_mask:0xf bank_mask:0xf
  v_dot2c_f32_bf16_dpp v74, v56, v189 row_newbcast:7 row_mask:0xf bank_mask:0xf
  v_dot2c_f32_bf16_dpp v75, v64, v189 row_newbcast:7 row_mask:0xf bank_mask:0xf
  v_dot2c_f32_bf16_dpp v76, v56, v190 row_newbcast:7 row_mask:0xf bank_mask:0xf
  v_dot2c_f32_bf16_dpp v77, v64, v190 row_newbcast:7 row_mask:0xf bank_mask:0xf
  v_dot2c_f32_bf16_dpp v78, v56, v191 row_newbcast:7 row_mask:0xf bank_mask:0xf
  v_dot2c_f32_bf16_dpp v79, v64, v191 row_newbcast:7 row_mask:0xf bank_mask:0xf
  s_add_u32 s92, s92, 110
  s_waitcnt lgkmcnt(0)
  v_readfirstlane_b32 s63, v31
  s_sub_u32 s93, s94, s92
  s_sub_u32 s43, s63, s93
  s_cmp_eq_u32 s63, 0x80000000
  s_cselect_b32 s43, 0, s43
  s_cselect_b32 s96, s61, 3
  s_cmp_gt_i32 s43, s13
  s_cselect_b32 s96, 2, s96
  s_cmp_lt_i32 s43, s14
  s_cselect_b32 s96, 4, s96
  s_cmp_lt_i32 s43, s15
  s_cselect_b32 s96, 6, s96
  s_mov_b32 s99, 2
  s_branch L_v2_next
L_v1_b3:
  s_waitcnt vmcnt(2)
  s_cmp_gt_u32 s99, 3
  s_cbranch_scc1 L_v1_b3s3
  s_add_u32 s42, s40, 57344
  buffer_load_dwordx4 v[188:191], v2, s[8:11], s42 offen offset:0 nt
L_v1_b3s3:
  v_dot2c_f32_bf16_dpp v72, v56, v176 row_newbcast:4 row_mask:0xf bank_mask:0xf
  v_dot2c_f32_bf16_dpp v73, v64, v176 row_newbcast:4 row_mask:0xf bank_mask:0xf
  v_dot2c_f32_bf16_dpp v74, v56, v177 row_newbcast:4 row_mask:0xf bank_mask:0xf
  v_dot2c_f32_bf16_dpp v75, v64, v177 row_newbcast:4 row_mask:0xf bank_mask:0xf
  v_dot2c_f32_bf16_dpp v76, v56, v178 row_newbcast:4 row_mask:0xf bank_mask:0xf
  v_dot2c_f32_bf16_dpp v77, v64, v178 row_newbcast:4 row_mask:0xf bank_mask:0xf
  v_dot2c_f32_bf16_dpp v78, v56, v179 row_newbcast:4 row_mask:0xf bank_mask:0xf
  v_dot2c_f32_bf16_dpp v79, v64, v179 row_newbcast:4 row_mask:0xf bank_mask:0xf
  s_waitcnt vmcnt(2)
  s_cmp_gt_u32 s99, 4
  s_cbranch_scc1 L_v1_b3s4
  s_add_u32 s42, s40, 65536
  buffer_load_dwordx4 v[192:195], v2, s[8:11], s42 offen offset:0 nt
L_v1_b3s4:
  v_dot2c_f32_bf16_dpp v72, v56, v180 row_newbcast:5 row_mask:0xf bank_mask:0xf
  v_dot2c_f32_bf16_dpp v73, v64, v180 row_newbcast:5 row_mask:0xf bank_mask:0xf
  v_dot2c_f32_bf16_dpp v74, v56, v181 row_newbcast:5 row_mask:0xf bank_mask:0xf
  v_dot2c_f32_bf16_dpp v75, v64, v181 row_newbcast:5 row_mask:0xf bank_mask:0xf
  v_dot2c_f32_bf16_dpp v76, v56, v182 row_newbcast:5 row_mask:0xf bank_mask:0xf
  v_dot2c_f32_bf16_dpp v77, v64, v182 row_newbcast:5 row_mask:0xf bank_mask:0xf
  v_dot2c_f32_bf16_dpp v78, v56, v183 row_newbcast:5 row_mask:0xf bank_mask:0xf
  v_dot2c_f32_bf16_dpp v79, v64, v183 row_newbcast:5 row_mask:0xf bank_mask:0xf
  s_waitcnt vmcnt(2)
  s_cmp_gt_u32 s99, 5
  s_cbranch_scc1 L_v1_b3s5
  s_add_u32 s42, s40, 73728
  buffer_load_dwordx4 v[196:199], v2, s[8:11], s42 offen offset:0 nt
L_v1_b3s5:
  s_memrealtime s[94:95]
  ds_read_b32 v31, v33 offset:6208
  v_dot2c_f32_bf16_dpp v72, v56, v184 row_newbcast:6 row_mask:0xf bank_mask:0xf
  v_dot2c_f32_bf16_dpp v73, v64, v184 row_newbcast:6 row_mask:0xf bank_mask:0xf
  v_dot2c_f32_bf16_dpp v74, v56, v185 row_newbcast:6 row_mask:0xf bank_mask:0xf
  v_dot2c_f32_bf16_dpp v75, v64, v185 row_newbcast:6 row_mask:0xf bank_mask:0xf
  v_dot2c_f32_bf16_dpp v76, v56, v186 row_newbcast:6 row_mask:0xf bank_mask:0xf
  v_dot2c_f32_bf16_dpp v77, v64, v186 row_newbcast:6 row_mask:0xf bank_mask:0xf
  v_dot2c_f32_bf16_dpp v78, v56, v187 row_newbcast:6 row_mask:0xf bank_mask:0xf
  v_dot2c_f32_bf16_dpp v79, v64, v187 row_newbcast:6 row_mask:0xf bank_mask:0xf
  s_waitcnt vmcnt(2)
  s_add_u32 s42, s40, 81920
  buffer_load_dwordx4 v[200:203], v2, s[8:11], s42 offen offset:0 nt
  v_dot2c_f32_bf16_dpp v72, v56, v188 row_newbcast:7 row_mask:0xf bank_mask:0xf
  v_dot2c_f32_bf16_dpp v73, v64, v188 row_newbcast:7 row_mask:0xf bank_mask:0xf
  v_dot2c_f32_bf16_dpp v74, v56, v189 row_newbcast:7 row_mask:0xf bank_mask:0xf
  v_dot2c_f32_bf16_dpp v75, v64, v189 row_newbcast:7 row_mask:0xf bank_mask:0xf
  v_dot2c_f32_bf16_dpp v76, v56, v190 row_newbcast:7 row_mask:0xf bank_mask:0xf
  v_dot2c_f32_bf16_dpp v77, v64, v190 row_newbcast:7 row_mask:0xf bank_mask:0xf
  v_dot2c_f32_bf16_dpp v78, v56, v191 row_newbcast:7 row_mask:0xf bank_mask:0xf
  v_dot2c_f32_bf16_dpp v79, v64, v191 row_newbcast:7 row_mask:0xf bank_mask:0xf
  s_add_u32 s92, s92, 110
  s_waitcnt lgkmcnt(0)
  v_readfirstlane_b32 s63, v31
  s_sub_u32 s93, s94, s92
  s_sub_u32 s43, s63, s93
  s_cmp_eq_u32 s63, 0x80000000
  s_cselect_b32 s43, 0, s43
  s_cselect_b32 s96, s61, 3
  s_cmp_gt_i32 s43, s13
  s_cselect_b32 s96, 2, s96
  s_cmp_lt_i32 s43, s14
  s_cselect_b32 s96, 4, s96
  s_cmp_lt_i32 s43, s15
  s_cselect_b32 s96, 6, s96
  s_mov_b32 s99, 3
  s_branch L_v2_next
L_v1_b4:
  s_waitcnt vmcnt(3)
  s_cmp_gt_u32 s99, 4
  s_cbranch_scc1 L_v1_b4s4
  s_add_u32 s42, s40, 65536
  buffer_load_dwordx4 v[192:195], v2, s[8:11], s42 offen offset:0 nt
L_v1_b4s4:
  v_dot2c_f32_bf16_dpp v72, v56, v176 row_newbcast:4 row_mask:0xf bank_mask:0xf
  v_dot2c_f32_bf16_dpp v73, v64, v176 row_newbcast:4 row_mask:0xf bank_mask:0xf
  v_dot2c_f32_bf16_dpp v74, v56, v177 row_newbcast:4 row_mask:0xf bank_mask:0xf
  v_dot2c_f32_bf16_dpp v75, v64, v177 row_newbcast:4 row_mask:0xf bank_mask:0xf
  v_dot2c_f32_bf16_dpp v76, v56, v178 row_newbcast:4 row_mask:0xf bank_mask:0xf
  v_dot2c_f32_bf16_dpp v77, v64, v178 row_newbcast:4 row_mask:0xf bank_mask:0xf
  v_dot2c_f32_bf16_dpp v78, v56, v179 row_newbcast:4 row_mask:0xf bank_mask:0xf
  v_dot2c_f32_bf16_dpp v79, v64, v179 row_newbcast:4 row_mask:0xf bank_mask:0xf
  s_waitcnt vmcnt(3)
  s_cmp_gt_u32 s99, 5
  s_cbranch_scc1 L_v1_b4s5
  s_add_u32 s42, s40, 73728
  buffer_load_dwordx4 v[196:199], v2, s[8:11], s42 offen offset:0 nt
L_v1_b4s5:
  v_dot2c_f32_bf16_dpp v72, v56, v180 row_newbcast:5 row_mask:0xf bank_mask:0xf
  v_dot2c_f32_bf16_dpp v73, v64, v180 row_newbcast:5 row_mask:0xf bank_mask:0xf
  v_dot2c_f32_bf16_dpp v74, v56, v181 row_newbcast:5 row_mask:0xf bank_mask:0xf
  v_dot2c_f32_bf16_dpp v75, v64, v181 row_newbcast:5 row_mask:0xf bank_mask:0xf
  v_dot2c_f32_bf16_dpp v76, v56, v182 row_newbcast:5 row_mask:0xf bank_mask:0xf
  v_dot2c_f32_bf16_dpp v77, v64, v182 row_newbcast:5 row_mask:0xf bank_mask:0xf
  v_dot2c_f32_bf16_dpp v78, v56, v183 row_newbcast:5 row_mask:0xf bank_mask:0xf
  v_dot2c_f32_bf16_dpp v79, v64, v183 row_newbcast:5 row_mask:0xf bank_mask:0xf
  s_waitcnt vmcnt(3)
  s_add_u32 s42, s40, 81920
  buffer_load_dwordx4 v[200:203], v2, s[8:11], s42 offen offset:0 nt
  s_memrealtime s[94:95]
  ds_read_b32 v31, v33 offset:6208
  v_dot2c_f32_bf16_dpp v72, v56, v184 row_newbcast:6 row_mask:0xf bank_mask:0xf
  v_dot2c_f32_bf16_dpp v73, v64, v184 row_newbcast:6 row_mask:0xf bank_mask:0xf
  v_dot2c_f32_bf16_dpp v74, v56, v185 row_newbcast:6 row_mask:0xf bank_mask:0xf
  v_dot2c_f32_bf16_dpp v75, v64, v185 row_newbcast:6 row_mask:0xf bank_mask:0xf
  v_dot2c_f32_bf16_dpp v76, v56, v186 row_newbcast:6 row_mask:0xf bank_mask:0xf
  v_dot2c_f32_bf16_dpp v77, v64, v186 row_newbcast:6 row_mask:0xf bank_mask:0xf
  v_dot2c_f32_bf16_dpp v78, v56, v187 row_newbcast:6 row_mask:0xf bank_mask:0xf
  v_dot2c_f32_bf16_dpp v79, v64, v187 row_newbcast:6 row_mask:0xf bank_mask:0xf
  s_waitcnt vmcnt(3)
  s_add_u32 s42, s40, 90112
  buffer_load_dwordx4 v[204:207], v2, s[8:11], s42 offen offset:0 nt
  v_dot2c_f32_bf16_dpp v72, v56, v188 row_newbcast:7 row_mask:0xf bank_mask:0xf
  v_dot2c_f32_bf16_dpp v73, v64, v188 row_newbcast:7 row_mask:0xf bank_mask:0xf
  v_dot2c_f32_bf16_dpp v74, v56, v189 row_newbcast:7 row_mask:0xf bank_mask:0xf
  v_dot2c_f32_bf16_dpp v75, v64, v189 row_newbcast:7 row_mask:0xf bank_mask:0xf
  v_dot2c_f32_bf16_dpp v76, v56, v190 row_newbcast:7 row_mask:0xf bank_mask:0xf
  v_dot2c_f32_bf16_dpp v77, v64, v190 row_newbcast:7 row_mask:0xf bank_mask:0xf
  v_dot2c_f32_bf16_dpp v78, v56, v191 row_newbcast:7 row_mask:0xf bank_mask:0xf
  v_dot2c_f32_bf16_dpp v79, v64, v191 row_newbcast:7 row_mask:0xf bank_mask:0xf
  s_add_u32 s92, s92, 110
  s_waitcnt lgkmcnt(0)
  v_readfirstlane_b32 s63, v31
  s_sub_u32 s93, s94, s92
  s_sub_u32 s43, s63, s93
  s_cmp_eq_u32 s63, 0x80000000
  s_cselect_b32 s43, 0, s43
  s_cselect_b32 s96, s61, 3
  s_cmp_gt_i32 s43, s13
  s_cselect_b32 s96, 2, s96
  s_cmp_lt_i32 s43, s14
  s_cselect_b32 s96, 4, s96
  s_cmp_lt_i32 s43, s15
  s_cselect_b32 s96, 6, s96
  s_mov_b32 s99, 4
  s_branch L_v2_next
L_v1_b6:
  s_waitcnt vmcnt(5)
  s_add_u32 s42, s40, 81920
  buffer_load_dwordx4 v[200:203], v2, s[8:11], s42 offen offset:0 nt
  v_dot2c_f32_bf16_dpp v72, v56, v176 row_newbcast:4 row_mask:0xf bank_mask:0xf
  v_dot2c_f32_bf16_dpp v73, v64, v176 row_newbcast:4 row_mask:0xf bank_mask:0xf
  v_dot2c_f32_bf16_dpp v74, v56, v177 row_newbcast:4 row_mask:0xf bank_mask:0xf
  v_dot2c_f32_bf16_dpp v75, v64, v177 row_newbcast:4 row_mask:0xf bank_mask:0xf
  v_dot2c_f32_bf16_dpp v76, v56, v178 row_newbcast:4 row_mask:0xf bank_mask:0xf
  v_dot2c_f32_bf16_dpp v77, v64, v178 row_newbcast:4 row_mask:0xf bank_mask:0xf
  v_dot2c_f32_bf16_dpp v78, v56, v179 row_newbcast:4 row_mask:0xf bank_mask:0xf
  v_dot2c_f32_bf16_dpp v79, v64, v179 row_newbcast:4 row_mask:0xf bank_mask:0xf
  s_waitcnt vmcnt(5)
  s_add_u32 s42, s40, 90112
  buffer_load_dwordx4 v[204:207], v2, s[8:11], s42 offen offset:0 nt
  v_dot2c_f32_bf16_dpp v72, v56, v180 row_newbcast:5 row_mask:0xf bank_mask:0xf
  v_dot2c_f32_bf16_dpp v73, v64, v180 row_newbcast:5 row_mask:0xf bank_mask:0xf
  v_dot2c_f32_bf16_dpp v74, v56, v181 row_newbcast:5 row_mask:0xf bank_mask:0xf
  v_dot2c_f32_bf16_dpp v75, v64, v181 row_newbcast:5 row_mask:0xf bank_mask:0xf
  v_dot2c_f32_bf16_dpp v76, v56, v182 row_newbcast:5 row_mask:0xf bank_mask:0xf
  v_dot2c_f32_bf16_dpp v77, v64, v182 row_newbcast:5 row_mask:0xf bank_mask:0xf
  v_dot2c_f32_bf16_dpp v78, v56, v183 row_newbcast:5 row_mask:0xf bank_mask:0xf
  v_dot2c_f32_bf16_dpp v79, v64, v183 row_newbcast:5 row_mask:0xf bank_mask:0xf
  s_waitcnt vmcnt(5)
  s_add_u32 s42, s40, 98304
  buffer_load_dwordx4 v[208:211], v2, s[8:11], s42 offen offset:0 nt
  s_memrealtime s[94:95]
  ds_read_b32 v31, v33 offset:6208
  v_dot2c_f32_bf16_dpp v72, v56, v184 row_newbcast:6 row_mask:0xf bank_mask:0xf
  v_dot2c_f32_bf16_dpp v73, v64, v184 row_newbcast:6 row_mask:0xf bank_mask:0xf
  v_dot2c_f32_bf16_dpp v74, v56, v185 row_newbcast:6 row_mask:0xf bank_mask:0xf
  v_dot2c_f32_bf16_dpp v75, v64, v185 row_newbcast:6 row_mask:0xf bank_mask:0xf
  v_dot2c_f32_bf16_dpp v76, v56, v186 row_newbcast:6 row_mask:0xf bank_mask:0xf
  v_dot2c_f32_bf16_dpp v77, v64, v186 row_newbcast:6 row_mask:0xf bank_mask:0xf
  v_dot2c_f32_bf16_dpp v78, v56, v187 row_newbcast:6 row_mask:0xf bank_mask:0xf
  v_dot2c_f32_bf16_dpp v79, v64, v187 row_newbcast:6 row_mask:0xf bank_mask:0xf
  s_waitcnt vmcnt(5)
  s_add_u32 s42, s40, 106496
  buffer_load_dwordx4 v[212:215], v2, s[8:11], s42 offen offset:0 nt
  v_dot2c_f32_bf16_dpp v72, v56, v188 row_newbcast:7 row_mask:0xf bank_mask:0xf
  v_dot2c_f32_bf16_dpp v73, v64, v188 row_newbcast:7 row_mask:0xf bank_mask:0xf
  v_dot2c_f32_bf16_dpp v74, v56, v189 row_newbcast:7 row_mask:0xf bank_mask:0xf
  v_dot2c_f32_bf16_dpp v75, v64, v189 row_newbcast:7 row_mask:0xf bank_mask:0xf
  v_dot2c_f32_bf16_dpp v76, v56, v190 row_newbcast:7 row_mask:0xf bank_mask:0xf
  v_dot2c_f32_bf16_dpp v77, v64, v190 row_newbcast:7 row_mask:0xf bank_mask:0xf
  v_dot2c_f32_bf16_dpp v78, v56, v191 row_newbcast:7 row_mask:0xf bank_mask:0xf
  v_dot2c_f32_bf16_dpp v79, v64, v191 row_newbcast:7 row_mask:0xf bank_mask:0xf
  s_add_u32 s92, s92, 110
  s_waitcnt lgkmcnt(0)
  v_readfirstlane_b32 s63, v31
  s_sub_u32 s93, s94, s92
  s_sub_u32 s43, s63, s93
  s_cmp_eq_u32 s63, 0x80000000
  s_cselect_b32 s43, 0, s43
  s_cselect_b32 s96, s61, 3
  s_cmp_gt_i32 s43, s13
  s_cselect_b32 s96, 2, s96
  s_cmp_lt_i32 s43, s14
  s_cselect_b32 s96, 4, s96
  s_cmp_lt_i32 s43, s15
  s_cselect_b32 s96, 6, s96
  s_mov_b32 s99, 6
  s_branch L_v2_next
L_v2_next:
  s_cmp_gt_u32 s99, 2
  s_cbranch_scc1 L_v2_u2
  s_cmp_le_u32 s96, 2
  s_cbranch_scc1 L_v2_u2
  s_add_u32 s42, s40, 81920
  buffer_load_dwordx4 v[200:203], v2, s[8:11], s42 offen offset:0 nt
L_v2_u2:
  s_cmp_gt_u32 s99, 3
  s_cbranch_scc1 L_v2_u3
  s_cmp_le_u32 s96, 3
  s_cbranch_scc1 L_v2_u3
  s_add_u32 s42, s40, 90112
  buffer_load_dwordx4 v[204:207], v2, s[8:11], s42 offen offset:0 nt
L_v2_u3:
  s_cmp_gt_u32 s99, 4
  s_cbranch_scc1 L_v2_u4
  s_cmp_le_u32 s96, 4
  s_cbranch_scc1 L_v2_u4
  s_add_u32 s42, s40, 98304
  buffer_load_dwordx4 v[208:211], v2, s[8:11], s42 offen offset:0 nt
L_v2_u4:
  s_cmp_gt_u32 s99, 5
  s_cbranch_scc1 L_v2_u5
  s_cmp_le_u32 s96, 5
  s_cbranch_scc1 L_v2_u5
  s_add_u32 s42, s40, 106496
  buffer_load_dwordx4 v[212:215], v2, s[8:11], s42 offen offset:0 nt
L_v2_u5:
  s_cmp_eq_u32 s96, 3
  s_cbranch_scc1 L_v2_b3
  s_cmp_eq_u32 s96, 4
  s_cbranch_scc1 L_v2_b4
  s_cmp_eq_u32 s96, 6
  s_cbranch_scc1 L_v2_b6
L_v2_b2:
  s_waitcnt vmcnt(1)
  s_cmp_gt_u32 s99, 2
  s_cbranch_scc1 L_v2_b2s2
  s_add_u32 s42, s40, 81920
  buffer_load_dwordx4 v[200:203], v2, s[8:11], s42 offen offset:0 nt
L_v2_b2s2:
  v_dot2c_f32_bf16_dpp v72, v56, v192 row_newbcast:8 row_mask:0xf bank_mask:0xf
  v_dot2c_f32_bf16_dpp v73, v64, v192 row_newbcast:8 row_mask:0xf bank_mask:0xf
  v_dot2c_f32_bf16_dpp v74, v56, v193 row_newbcast:8 row_mask:0xf bank_mask:0xf
  v_dot2c_f32_bf16_dpp v75, v64, v193 row_newbcast:8 row_mask:0xf bank_mask:0xf
  v_dot2c_f32_bf16_dpp v76, v56, v194 row_newbcast:8 row_mask:0xf bank_mask:0xf
  v_dot2c_f32_bf16_dpp v77, v64, v194 row_newbcast:8 row_mask:0xf bank_mask:0xf
  v_dot2c_f32_bf16_dpp v78, v56, v195 row_newbcast:8 row_mask:0xf bank_mask:0xf
  v_dot2c_f32_bf16_dpp v79, v64, v195 row_newbcast:8 row_mask:0xf bank_mask:0xf
  s_waitcnt vmcnt(1)
  s_cmp_gt_u32 s99, 3
  s_cbranch_scc1 L_v2_b2s3
  s_add_u32 s42, s40, 90112
  buffer_load_dwordx4 v[204:207], v2, s[8:11], s42 offen offset:0 nt
L_v2_b2s3:
  v_dot2c_f32_bf16_dpp v72, v56, v196 row_newbcast:9 row_mask:0xf bank_mask:0xf
  v_dot2c_f32_bf16_dpp v73, v64, v196 row_newbcast:9 row_mask:0xf bank_mask:0xf
  v_dot2c_f32_bf16_dpp v74, v56, v197 row_newbcast:9 row_mask:0xf bank_mask:0xf
  v_dot2c_f32_bf16_dpp v75, v64, v197 row_newbcast:9 row_mask:0xf bank_mask:0xf
  v_dot2c_f32_bf16_dpp v76, v56, v198 row_newbcast:9 row_mask:0xf bank_mask:0xf
  v_dot2c_f32_bf16_dpp v77, v64, v198 row_newbcast:9 row_mask:0xf bank_mask:0xf
  v_dot2c_f32_bf16_dpp v78, v56, v199 row_newbcast:9 row_mask:0xf bank_mask:0xf
  v_dot2c_f32_bf16_dpp v79, v64, v199 row_newbcast:9 row_mask:0xf bank_mask:0xf
  s_waitcnt vmcnt(1)
  s_cmp_gt_u32 s99, 4
  s_cbranch_scc1 L_v2_b2s4
  s_add_u32 s42, s40, 98304
  buffer_load_dwordx4 v[208:211], v2, s[8:11], s42 offen offset:0 nt
L_v2_b2s4:
  s_memrealtime s[94:95]
  ds_read_b32 v31, v33 offset:6208
  v_dot2c_f32_bf16_dpp v72, v56, v200 row_newbcast:10 row_mask:0xf bank_mask:0xf
  v_dot2c_f32_bf16_dpp v73, v64, v200 row_newbcast:10 row_mask:0xf bank_mask:0xf
  v_dot2c_f32_bf16_dpp v74, v56, v201 row_newbcast:10 row_mask:0xf bank_mask:0xf
  v_dot2c_f32_bf16_dpp v75, v64, v201 row_newbcast:10 row_mask:0xf bank_mask:0xf
  v_dot2c_f32_bf16_dpp v76, v56, v202 row_newbcast:10 row_mask:0xf bank_mask:0xf
  v_dot2c_f32_bf16_dpp v77, v64, v202 row_newbcast:10 row_mask:0xf bank_mask:0xf
  v_dot2c_f32_bf16_dpp v78, v56, v203 row_newbcast:10 row_mask:0xf bank_mask:0xf
  v_dot2c_f32_bf16_dpp v79, v64, v203 row_newbcast:10 row_mask:0xf bank_mask:0xf
  s_waitcnt vmcnt(1)
  s_cmp_gt_u32 s99, 5
  s_cbranch_scc1 L_v2_b2s5
  s_add_u32 s42, s40, 106496
  buffer_load_dwordx4 v[212:215], v2, s[8:11], s42 offen offset:0 nt
L_v2_b2s5:
  v_dot2c_f32_bf16_dpp v72, v56, v204 row_newbcast:11 row_mask:0xf bank_mask:0xf
  v_dot2c_f32_bf16_dpp v73, v64, v204 row_newbcast:11 row_mask:0xf bank_mask:0xf
  v_dot2c_f32_bf16_dpp v74, v56, v205 row_newbcast:11 row_mask:0xf bank_mask:0xf
  v_dot2c_f32_bf16_dpp v75, v64, v205 row_newbcast:11 row_mask:0xf bank_mask:0xf
  v_dot2c_f32_bf16_dpp v76, v56, v206 row_newbcast:11 row_mask:0xf bank_mask:0xf
  v_dot2c_f32_bf16_dpp v77, v64, v206 row_newbcast:11 row_mask:0xf bank_mask:0xf
  v_dot2c_f32_bf16_dpp v78, v56, v207 row_newbcast:11 row_mask:0xf bank_mask:0xf
  v_dot2c_f32_bf16_dpp v79, v64, v207 row_newbcast:11 row_mask:0xf bank_mask:0xf
  s_add_u32 s92, s92, 110
  s_waitcnt lgkmcnt(0)
  v_readfirstlane_b32 s63, v31
  s_sub_u32 s93, s94, s92
  s_sub_u32 s43, s63, s93
  s_cmp_eq_u32 s63, 0x80000000
  s_cselect_b32 s43, 0, s43
  s_cselect_b32 s96, s61, 3
  s_cmp_gt_i32 s43, s13
  s_cselect_b32 s96, 2, s96
  s_cmp_lt_i32 s43, s14
  s_cselect_b32 s96, 4, s96
  s_cmp_lt_i32 s43, s15
  s_cselect_b32 s96, 6, s96
  s_mov_b32 s99, 2
  s_branch L_v3_next
L_v2_b3:
  s_waitcnt vmcnt(2)
  s_cmp_gt_u32 s99, 3
  s_cbranch_scc1 L_v2_b3s3
  s_add_u32 s42, s40, 90112
  buffer_load_dwordx4 v[204:207], v2, s[8:11], s42 offen offset:0 nt
L_v2_b3s3:
  v_dot2c_f32_bf16_dpp v72, v56, v192 row_newbcast:8 row_mask:0xf bank_mask:0xf
  v_dot2c_f32_bf16_dpp v73, v64, v192 row_newbcast:8 row_mask:0xf bank_mask:0xf
  v_dot2c_f32_bf16_dpp v74, v56, v193 row_newbcast:8 row_mask:0xf bank_mask:0xf
  v_dot2c_f32_bf16_dpp v75, v64, v193 row_newbcast:8 row_mask:0xf bank_mask:0xf
  v_dot2c_f32_bf16_dpp v76, v56, v194 row_newbcast:8 row_mask:0xf bank_mask:0xf
  v_dot2c_f32_bf16_dpp v77, v64, v194 row_newbcast:8 row_mask:0xf bank_mask:0xf
  v_dot2c_f32_bf16_dpp v78, v56, v195 row_newbcast:8 row_mask:0xf bank_mask:0xf
  v_dot2c_f32_bf16_dpp v79, v64, v195 row_newbcast:8 row_mask:0xf bank_mask:0xf
  s_waitcnt vmcnt(2)
  s_cmp_gt_u32 s99, 4
  s_cbranch_scc1 L_v2_b3s4
  s_add_u32 s42, s40, 98304
  buffer_load_dwordx4 v[208:211], v2, s[8:11], s42 offen offset:0 nt
L_v2_b3s4:
  v_dot2c_f32_bf16_dpp v72, v56, v196 row_newbcast:9 row_mask:0xf bank_mask:0xf
  v_dot2c_f32_bf16_dpp v73, v64, v196 row_newbcast:9 row_mask:0xf bank_mask:0xf
  v_dot2c_f32_bf16_dpp v74, v56, v197 row_newbcast:9 row_mask:0xf bank_mask:0xf
  v_dot2c_f32_bf16_dpp v75, v64, v197 row_newbcast:9 row_mask:0xf bank_mask:0xf
  v_dot2c_f32_bf16_dpp v76, v56, v198 row_newbcast:9 row_mask:0xf bank_mask:0xf
  v_dot2c_f32_bf16_dpp v77, v64, v198 row_newbcast:9 row_mask:0xf bank_mask:0xf
  v_dot2c_f32_bf16_dpp v78, v56, v199 row_newbcast:9 row_mask:0xf bank_mask:0xf
  v_dot2c_f32_bf16_dpp v79, v64, v199 row_newbcast:9 row_mask:0xf bank_mask:0xf
  s_waitcnt vmcnt(2)
  s_cmp_gt_u32 s99, 5
  s_cbranch_scc1 L_v2_b3s5
  s_add_u32 s42, s40, 106496
  buffer_load_dwordx4 v[212:215], v2, s[8:11], s42 offen offset:0 nt
L_v2_b3s5:
  s_memrealtime s[94:95]
  ds_read_b32 v31, v33 offset:6208
  v_dot2c_f32_bf16_dpp v72, v56, v200 row_newbcast:10 row_mask:0xf bank_mask:0xf
  v_dot2c_f32_bf16_dpp v73, v64, v200 row_newbcast:10 row_mask:0xf bank_mask:0xf
  v_dot2c_f32_bf16_dpp v74, v56, v201 row_newbcast:10 row_mask:0xf bank_mask:0xf
  v_dot2c_f32_bf16_dpp v75, v64, v201 row_newbcast:10 row_mask:0xf bank_mask:0xf
  v_dot2c_f32_bf16_dpp v76, v56, v202 row_newbcast:10 row_mask:0xf bank_mask:0xf
  v_dot2c_f32_bf16_dpp v77, v64, v202 row_newbcast:10 row_mask:0xf bank_mask:0xf
  v_dot2c_f32_bf16_dpp v78, v56, v203 row_newbcast:10 row_mask:0xf bank_mask:0xf
  v_dot2c_f32_bf16_dpp v79, v64, v203 row_newbcast:10 row_mask:0xf bank_mask:0xf
  s_waitcnt vmcnt(2)
  s_add_u32 s42, s40, 114688
  buffer_load_dwordx4 v[216:219], v2, s[8:11], s42 offen offset:0 nt
  v_dot2c_f32_bf16_dpp v72, v56, v204 row_newbcast:11 row_mask:0xf bank_mask:0xf
  v_dot2c_f32_bf16_dpp v73, v64, v204 row_newbcast:11 row_mask:0xf bank_mask:0xf
  v_dot2c_f32_bf16_dpp v74, v56, v205 row_newbcast:11 row_mask:0xf bank_mask:0xf
  v_dot2c_f32_bf16_dpp v75, v64, v205 row_newbcast:11 row_mask:0xf bank_mask:0xf
  v_dot2c_f32_bf16_dpp v76, v56, v206 row_newbcast:11 row_mask:0xf bank_mask:0xf
  v_dot2c_f32_bf16_dpp v77, v64, v206 row_newbcast:11 row_mask:0xf bank_mask:0xf
  v_dot2c_f32_bf16_dpp v78, v56, v207 row_newbcast:11 row_mask:0xf bank_mask:0xf
  v_dot2c_f32_bf16_dpp v79, v64, v207 row_newbcast:11 row_mask:0xf bank_mask:0xf
  s_add_u32 s92, s92, 110
  s_waitcnt lgkmcnt(0)
  v_readfirstlane_b32 s63, v31
  s_sub_u32 s93, s94, s92
  s_sub_u32 s43, s63, s93
  s_cmp_eq_u32 s63, 0x80000000
  s_cselect_b32 s43, 0, s43
  s_cselect_b32 s96, s61, 3
  s_cmp_gt_i32 s43, s13
  s_cselect_b32 s96, 2, s96
  s_cmp_lt_i32 s43, s14
  s_cselect_b32 s96, 4, s96
  s_cmp_lt_i32 s43, s15
  s_cselect_b32 s96, 6, s96
  s_mov_b32 s99, 3
  s_branch L_v3_next
L_v2_b4:
  s_waitcnt vmcnt(3)
  s_cmp_gt_u32 s99, 4
  s_cbranch_scc1 L_v2_b4s4
  s_add_u32 s42, s40, 98304
  buffer_load_dwordx4 v[208:211], v2, s[8:11], s42 offen offset:0 nt
L_v2_b4s4:
  v_dot2c_f32_bf16_dpp v72, v56, v192 row_newbcast:8 row_mask:0xf bank_mask:0xf
  v_dot2c_f32_bf16_dpp v73, v64, v192 row_newbcast:8 row_mask:0xf bank_mask:0xf
  v_dot2c_f32_bf16_dpp v74, v56, v193 row_newbcast:8 row_mask:0xf bank_mask:0xf
  v_dot2c_f32_bf16_dpp v75, v64, v193 row_newbcast:8 row_mask:0xf bank_mask:0xf
  v_dot2c_f32_bf16_dpp v76, v56, v194 row_newbcast:8 row_mask:0xf bank_mask:0xf
  v_dot2c_f32_bf16_dpp v77, v64, v194 row_newbcast:8 row_mask:0xf bank_mask:0xf
  v_dot2c_f32_bf16_dpp v78, v56, v195 row_newbcast:8 row_mask:0xf bank_mask:0xf
  v_dot2c_f32_bf16_dpp v79, v64, v195 row_newbcast:8 row_mask:0xf bank_mask:0xf
  s_waitcnt vmcnt(3)
  s_cmp_gt_u32 s99, 5
  s_cbranch_scc1 L_v2_b4s5
  s_add_u32 s42, s40, 106496
  buffer_load_dwordx4 v[212:215], v2, s[8:11], s42 offen offset:0 nt
L_v2_b4s5:
  v_dot2c_f32_bf16_dpp v72, v56, v196 row_newbcast:9 row_mask:0xf bank_mask:0xf
  v_dot2c_f32_bf16_dpp v73, v64, v196 row_newbcast:9 row_mask:0xf bank_mask:0xf
  v_dot2c_f32_bf16_dpp v74, v56, v197 row_newbcast:9 row_mask:0xf bank_mask:0xf
  v_dot2c_f32_bf16_dpp v75, v64, v197 row_newbcast:9 row_mask:0xf bank_mask:0xf
  v_dot2c_f32_bf16_dpp v76, v56, v198 row_newbcast:9 row_mask:0xf bank_mask:0xf
  v_dot2c_f32_bf16_dpp v77, v64, v198 row_newbcast:9 row_mask:0xf bank_mask:0xf
  v_dot2c_f32_bf16_dpp v78, v56, v199 row_newbcast:9 row_mask:0xf bank_mask:0xf
  v_dot2c_f32_bf16_dpp v79, v64, v199 row_newbcast:9 row_mask:0xf bank_mask:0xf
  s_waitcnt vmcnt(3)
  s_add_u32 s42, s40, 114688
  buffer_load_dwordx4 v[216:219], v2, s[8:11], s42 offen offset:0 nt
  s_memrealtime s[94:95]
  ds_read_b32 v31, v33 offset:6208
  v_dot2c_f32_bf16_dpp v72, v56, v200 row_newbcast:10 row_mask:0xf bank_mask:0xf
  v_dot2c_f32_bf16_dpp v73, v64, v200 row_newbcast:10 row_mask:0xf bank_mask:0xf
  v_dot2c_f32_bf16_dpp v74, v56, v201 row_newbcast:10 row_mask:0xf bank_mask:0xf
  v_dot2c_f32_bf16_dpp v75, v64, v201 row_newbcast:10 row_mask:0xf bank_mask:0xf
  v_dot2c_f32_bf16_dpp v76, v56, v202 row_newbcast:10 row_mask:0xf bank_mask:0xf
  v_dot2c_f32_bf16_dpp v77, v64, v202 row_newbcast:10 row_mask:0xf bank_mask:0xf
  v_dot2c_f32_bf16_dpp v78, v56, v203 row_newbcast:10 row_mask:0xf bank_mask:0xf
  v_dot2c_f32_bf16_dpp v79, v64, v203 row_newbcast:10 row_mask:0xf bank_mask:0xf
  s_waitcnt vmcnt(3)
  s_add_u32 s42, s40, 122880
  buffer_load_dwordx4 v[220:223], v2, s[8:11], s42 offen offset:0 nt
  v_dot2c_f32_bf16_dpp v72, v56, v204 row_newbcast:11 row_mask:0xf bank_mask:0xf
  v_dot2c_f32_bf16_dpp v73, v64, v204 row_newbcast:11 row_mask:0xf bank_mask:0xf
  v_dot2c_f32_bf16_dpp v74, v56, v205 row_newbcast:11 row_mask:0xf bank_mask:0xf
  v_dot2c_f32_bf16_dpp v75, v64, v205 row_newbcast:11 row_mask:0xf bank_mask:0xf
  v_dot2c_f32_bf16_dpp v76, v56, v206 row_newbcast:11 row_mask:0xf bank_mask:0xf
  v_dot2c_f32_bf16_dpp v77, v64, v206 row_newbcast:11 row_mask:0xf bank_mask:0xf
  v_dot2c_f32_bf16_dpp v78, v56, v207 row_newbcast:11 row_mask:0xf bank_mask:0xf
  v_dot2c_f32_bf16_dpp v79, v64, v207 row_newbcast:11 row_mask:0xf bank_mask:0xf
  s_add_u32 s92, s92, 110
  s_waitcnt lgkmcnt(0)
  v_readfirstlane_b32 s63, v31
  s_sub_u32 s93, s94, s92
  s_sub_u32 s43, s63, s93
  s_cmp_eq_u32 s63, 0x80000000
  s_cselect_b32 s43, 0, s43
  s_cselect_b32 s96, s61, 3
  s_cmp_gt_i32 s43, s13
  s_cselect_b32 s96, 2, s96
  s_cmp_lt_i32 s43, s14
  s_cselect_b32 s96, 4, s96
  s_cmp_lt_i32 s43, s15
  s_cselect_b32 s96, 6, s96
  s_mov_b32 s99, 4
  s_branch L_v3_next
L_v2_b6:
  s_waitcnt vmcnt(5)
  s_add_u32 s42, s40, 114688
  buffer_load_dwordx4 v[216:219], v2, s[8:11], s42 offen offset:0 nt
  v_dot2c_f32_bf16_dpp v72, v56, v192 row_newbcast:8 row_mask:0xf bank_mask:0xf
  v_dot2c_f32_bf16_dpp v73, v64, v192 row_newbcast:8 row_mask:0xf bank_mask:0xf
  v_dot2c_f32_bf16_dpp v74, v56, v193 row_newbcast:8 row_mask:0xf bank_mask:0xf
  v_dot2c_f32_bf16_dpp v75, v64, v193 row_newbcast:8 row_mask:0xf bank_mask:0xf
  v_dot2c_f32_bf16_dpp v76, v56, v194 row_newbcast:8 row_mask:0xf bank_mask:0xf
  v_dot2c_f32_bf16_dpp v77, v64, v194 row_newbcast:8 row_mask:0xf bank_mask:0xf
  v_dot2c_f32_bf16_dpp v78, v56, v195 row_newbcast:8 row_mask:0xf bank_mask:0xf
  v_dot2c_f32_bf16_dpp v79, v64, v195 row_newbcast:8 row_mask:0xf bank_mask:0xf
  s_waitcnt vmcnt(5)
  s_add_u32 s42, s40, 122880
  buffer_load_dwordx4 v[220:223], v2, s[8:11], s42 offen offset:0 nt
  v_dot2c_f32_bf16_dpp v72, v56, v196 row_newbcast:9 row_mask:0xf bank_mask:0xf
  v_dot2c_f32_bf16_dpp v73, v64, v196 row_newbcast:9 row_mask:0xf bank_mask:0xf
  v_dot2c_f32_bf16_dpp v74, v56, v197 row_newbcast:9 row_mask:0xf bank_mask:0xf
  v_dot2c_f32_bf16_dpp v75, v64, v197 row_newbcast:9 row_mask:0xf bank_mask:0xf
  v_dot2c_f32_bf16_dpp v76, v56, v198 row_newbcast:9 row_mask:0xf bank_mask:0xf
  v_dot2c_f32_bf16_dpp v77, v64, v198 row_newbcast:9 row_mask:0xf bank_mask:0xf
  v_dot2c_f32_bf16_dpp v78, v56, v199 row_newbcast:9 row_mask:0xf bank_mask:0xf
  v_dot2c_f32_bf16_dpp v79, v64, v199 row_newbcast:9 row_mask:0xf bank_mask:0xf
  s_waitcnt vmcnt(5)
  buffer_load_dwordx4 v[160:163], v2, s[8:11], s97 offen offset:0 nt
  s_memrealtime s[94:95]
  ds_read_b32 v31, v33 offset:6208
  v_dot2c_f32_bf16_dpp v72, v56, v200 row_newbcast:10 row_mask:0xf bank_mask:0xf
  v_dot2c_f32_bf16_dpp v73, v64, v200 row_newbcast:10 row_mask:0xf bank_mask:0xf
  v_dot2c_f32_bf16_dpp v74, v56, v201 row_newbcast:10 row_mask:0xf bank_mask:0xf
  v_dot2c_f32_bf16_dpp v75, v64, v201 row_newbcast:10 row_mask:0xf bank_mask:0xf
  v_dot2c_f32_bf16_dpp v76, v56, v202 row_newbcast:10 row_mask:0xf bank_mask:0xf
  v_dot2c_f32_bf16_dpp v77, v64, v202 row_newbcast:10 row_mask:0xf bank_mask:0xf
  v_dot2c_f32_bf16_dpp v78, v56, v203 row_newbcast:10 row_mask:0xf bank_mask:0xf
  v_dot2c_f32_bf16_dpp v79, v64, v203 row_newbcast:10 row_mask:0xf bank_mask:0xf
  s_waitcnt vmcnt(5)
  s_add_u32 s42, s97, 8192
  buffer_load_dwordx4 v[164:167], v2, s[8:11], s42 offen offset:0 nt
  v_dot2c_f32_bf16_dpp v72, v56, v204 row_newbcast:11 row_mask:0xf bank_mask:0xf
  v_dot2c_f32_bf16_dpp v73, v64, v204 row_newbcast:11 row_mask:0xf bank_mask:0xf
  v_dot2c_f32_bf16_dpp v74, v56, v205 row_newbcast:11 row_mask:0xf bank_mask:0xf
  v_dot2c_f32_bf16_dpp v75, v64, v205 row_newbcast:11 row_mask:0xf bank_mask:0xf
  v_dot2c_f32_bf16_dpp v76, v56, v206 row_newbcast:11 row_mask:0xf bank_mask:0xf
  v_dot2c_f32_bf16_dpp v77, v64, v206 row_newbcast:11 row_mask:0xf bank_mask:0xf
  v_dot2c_f32_bf16_dpp v78, v56, v207 row_newbcast:11 row_mask:0xf bank_mask:0xf
  v_dot2c_f32_bf16_dpp v79, v64, v207 row_newbcast:11 row_mask:0xf bank_mask:0xf
  s_add_u32 s92, s92, 110
  s_waitcnt lgkmcnt(0)
  v_readfirstlane_b32 s63, v31
  s_sub_u32 s93, s94, s92
  s_sub_u32 s43, s63, s93
  s_cmp_eq_u32 s63, 0x80000000
  s_cselect_b32 s43, 0, s43
  s_cselect_b32 s96, s61, 3
  s_cmp_gt_i32 s43, s13
  s_cselect_b32 s96, 2, s96
  s_cmp_lt_i32 s43, s14
  s_cselect_b32 s96, 4, s96
  s_cmp_lt_i32 s43, s15
  s_cselect_b32 s96, 6, s96
  s_mov_b32 s99, 6
  s_branch L_v3_next
L_v3_next:
  s_cmp_gt_u32 s99, 2
  s_cbranch_scc1 L_v3_u2
  s_cmp_le_u32 s96, 2
  s_cbranch_scc1 L_v3_u2
  s_add_u32 s42, s40, 114688
  buffer_load_dwordx4 v[216:219], v2, s[8:11], s42 offen offset:0 nt
L_v3_u2:
  s_cmp_gt_u32 s99, 3
  s_cbranch_scc1 L_v3_u3
  s_cmp_le_u32 s96, 3
  s_cbranch_scc1 L_v3_u3
  s_add_u32 s42, s40, 122880
  buffer_load_dwordx4 v[220:223], v2, s[8:11], s42 offen offset:0 nt
L_v3_u3:
  s_cmp_gt_u32 s99, 4
  s_cbranch_scc1 L_v3_u4
  s_cmp_le_u32 s96, 4
  s_cbranch_scc1 L_v3_u4
  buffer_load_dwordx4 v[160:163], v2, s[8:11], s97 offen offset:0 nt
L_v3_u4:
  s_cmp_gt_u32 s99, 5
  s_cbranch_scc1 L_v3_u5
  s_cmp_le_u32 s96, 5
  s_cbranch_scc1 L_v3_u5
  s_add_u32 s42, s97, 8192
  buffer_load_dwordx4 v[164:167], v2, s[8:11], s42 offen offset:0 nt
L_v3_u5:
  s_cmp_eq_u32 s96, 3
  s_cbranch_scc1 L_v3_b3
  s_cmp_eq_u32 s96, 4
  s_cbranch_scc1 L_v3_b4
  s_cmp_eq_u32 s96, 6
  s_cbranch_scc1 L_v3_b6
L_v3_b2:
  s_waitcnt vmcnt(1)
  s_cmp_gt_u32 s99, 2
  s_cbranch_scc1 L_v3_b2s2
  s_add_u32 s42, s40, 114688
  buffer_load_dwordx4 v[216:219], v2, s[8:11], s42 offen offset:0 nt
L_v3_b2s2:
  s_and_b32 s43, s98, 7
  s_cmp_lg_u32 s43, s3
  s_cbranch_scc1 L_c1_17
  v_subrev_u32 v34, s62, v34
  v_add_u32 v32, 0x1000, v34
  v_cmp_gt_u32 vcc, 0x2000, v32
  s_nop 1
  v_cndmask_b32 v34, 0, v34, vcc
  s_nop 1
  v_add_u32_dpp v34, v34, v34 row_ror:8 row_mask:0xf bank_mask:0xf
  s_nop 1
  v_add_u32_dpp v34, v34, v34 row_ror:4 row_mask:0xf bank_mask:0xf
  s_nop 1
  v_add_u32_dpp v34, v34, v34 row_ror:2 row_mask:0xf bank_mask:0xf
  s_nop 1
  v_add_u32_dpp v34, v34, v34 row_ror:1 row_mask:0xf bank_mask:0xf
  s_nop 0
  v_readlane_b32 s43, v34, 0
  s_nop 0
  s_ashr_i32 s43, s43, 3
  s_add_u32 s43, s43, s62
  v_mov_b32 v32, s43
  ds_write_b32 v33, v32 offset:6208
L_c1_17:
  v_dot2c_f32_bf16_dpp v72, v56, v208 row_newbcast:12 row_mask:0xf bank_mask:0xf
  v_dot2c_f32_bf16_dpp v73, v64, v208 row_newbcast:12 row_mask:0xf bank_mask:0xf
  v_dot2c_f32_bf16_dpp v74, v56, v209 row_newbcast:12 row_mask:0xf bank_mask:0xf
  v_dot2c_f32_bf16_dpp v75, v64, v209 row_newbcast:12 row_mask:0xf bank_mask:0xf
  v_dot2c_f32_bf16_dpp v76, v56, v210 row_newbcast:12 row_mask:0xf bank_mask:0xf
  v_dot2c_f32_bf16_dpp v77, v64, v210 row_newbcast:12 row_mask:0xf bank_mask:0xf
  v_dot2c_f32_bf16_dpp v78, v56, v211 row_newbcast:12 row_mask:0xf bank_mask:0xf
  v_dot2c_f32_bf16_dpp v79, v64, v211 row_newbcast:12 row_mask:0xf bank_mask:0xf
  s_waitcnt vmcnt(1)
  s_cmp_gt_u32 s99, 3
  s_cbranch_scc1 L_v3_b2s3
  s_add_u32 s42, s40, 122880
  buffer_load_dwordx4 v[220:223], v2, s[8:11], s42 offen offset:0 nt
L_v3_b2s3:
  v_dot2c_f32_bf16_dpp v72, v56, v212 row_newbcast:13 row_mask:0xf bank_mask:0xf
  v_dot2c_f32_bf16_dpp v73, v64, v212 row_newbcast:13 row_mask:0xf bank_mask:0xf
  v_dot2c_f32_bf16_dpp v74, v56, v213 row_newbcast:13 row_mask:0xf bank_mask:0xf
  v_dot2c_f32_bf16_dpp v75, v64, v213 row_newbcast:13 row_mask:0xf bank_mask:0xf
  v_dot2c_f32_bf16_dpp v76, v56, v214 row_newbcast:13 row_mask:0xf bank_mask:0xf
  v_dot2c_f32_bf16_dpp v77, v64, v214 row_newbcast:13 row_mask:0xf bank_mask:0xf
  v_dot2c_f32_bf16_dpp v78, v56, v215 row_newbcast:13 row_mask:0xf bank_mask:0xf
  v_dot2c_f32_bf16_dpp v79, v64, v215 row_newbcast:13 row_mask:0xf bank_mask:0xf
  s_waitcnt vmcnt(1)
  s_cmp_gt_u32 s99, 4
  s_cbranch_scc1 L_v3_b2s4
  buffer_load_dwordx4 v[160:163], v2, s[8:11], s97 offen offset:0 nt
L_v3_b2s4:
  s_memrealtime s[94:95]
  ds_read_b32 v31, v33 offset:6208
  v_dot2c_f32_bf16_dpp v72, v56, v216 row_newbcast:14 row_mask:0xf bank_mask:0xf
  v_dot2c_f32_bf16_dpp v73, v64, v216 row_newbcast:14 row_mask:0xf bank_mask:0xf
  v_dot2c_f32_bf16_dpp v74, v56, v217 row_newbcast:14 row_mask:0xf bank_mask:0xf
  v_dot2c_f32_bf16_dpp v75, v64, v217 row_newbcast:14 row_mask:0xf bank_mask:0xf
  v_dot2c_f32_bf16_dpp v76, v56, v218 row_newbcast:14 row_mask:0xf bank_mask:0xf
  v_dot2c_f32_bf16_dpp v77, v64, v218 row_newbcast:14 row_mask:0xf bank_mask:0xf
  v_dot2c_f32_bf16_dpp v78, v56, v219 row_newbcast:14 row_mask:0xf bank_mask:0xf
  v_dot2c_f32_bf16_dpp v79, v64, v219 row_newbcast:14 row_mask:0xf bank_mask:0xf
  s_waitcnt vmcnt(1)
  s_cmp_gt_u32 s99, 5
  s_cbranch_scc1 L_v3_b2s5
  s_add_u32 s42, s97, 8192
  buffer_load_dwordx4 v[164:167], v2, s[8:11], s42 offen offset:0 nt
L_v3_b2s5:
  v_dot2c_f32_bf16_dpp v72, v56, v220 row_newbcast:15 row_mask:0xf bank_mask:0xf
  v_dot2c_f32_bf16_dpp v73, v64, v220 row_newbcast:15 row_mask:0xf bank_mask:0xf
  v_dot2c_f32_bf16_dpp v74, v56, v221 row_newbcast:15 row_mask:0xf bank_mask:0xf
  v_dot2c_f32_bf16_dpp v75, v64, v221 row_newbcast:15 row_mask:0xf bank_mask:0xf
  v_dot2c_f32_bf16_dpp v76, v56, v222 row_newbcast:15 row_mask:0xf bank_mask:0xf
  v_dot2c_f32_bf16_dpp v77, v64, v222 row_newbcast:15 row_mask:0xf bank_mask:0xf
  v_dot2c_f32_bf16_dpp v78, v56, v223 row_newbcast:15 row_mask:0xf bank_mask:0xf
  v_dot2c_f32_bf16_dpp v79, v64, v223 row_newbcast:15 row_mask:0xf bank_mask:0xf
  s_cmp_eq_u32 s40, 917504
  s_cbranch_scc1 L_v_done
  v_mov_b32 v56, v57
  v_mov_b32 v64, v65
  v_mov_b32 v57, v58
  v_mov_b32 v65, v66
  v_mov_b32 v58, v59
  v_mov_b32 v66, v67
  v_mov_b32 v59, v60
  v_mov_b32 v67, v68
  v_mov_b32 v60, v61
  v_mov_b32 v68, v69
  v_mov_b32 v61, v62
  v_mov_b32 v69, v70
  v_mov_b32 v62, v63
  v_mov_b32 v70, v71
  s_add_u32 s92, s92, 110
  s_waitcnt lgkmcnt(0)
  v_readfirstlane_b32 s63, v31
  s_sub_u32 s93, s94, s92
  s_sub_u32 s43, s63, s93
  s_cmp_eq_u32 s63, 0x80000000
  s_cselect_b32 s43, 0, s43
  s_cselect_b32 s96, s61, 3
  s_cmp_gt_i32 s43, s13
  s_cselect_b32 s96, 2, s96
  s_cmp_lt_i32 s43, s14
  s_cselect_b32 s96, 4, s96
  s_cmp_lt_i32 s43, s15
  s_cselect_b32 s96, 6, s96
  s_mov_b32 s99, 2
  s_branch L_v0_next
L_v3_b3:
  s_waitcnt vmcnt(2)
  s_cmp_gt_u32 s99, 3
  s_cbranch_scc1 L_v3_b3s3
  s_add_u32 s42, s40, 122880
  buffer_load_dwordx4 v[220:223], v2, s[8:11], s42 offen offset:0 nt
L_v3_b3s3:
  s_and_b32 s43, s98, 7
  s_cmp_lg_u32 s43, s3
  s_cbranch_scc1 L_c1_18
  v_subrev_u32 v34, s62, v34
  v_add_u32 v32, 0x1000, v34
  v_cmp_gt_u32 vcc, 0x2000, v32
  s_nop 1
  v_cndmask_b32 v34, 0, v34, vcc
  s_nop 1
  v_add_u32_dpp v34, v34, v34 row_ror:8 row_mask:0xf bank_mask:0xf
  s_nop 1
  v_add_u32_dpp v34, v34, v34 row_ror:4 row_mask:0xf bank_mask:0xf
  s_nop 1
  v_add_u32_dpp v34, v34, v34 row_ror:2 row_mask:0xf bank_mask:0xf
  s_nop 1
  v_add_u32_dpp v34, v34, v34 row_ror:1 row_mask:0xf bank_mask:0xf
  s_nop 0
  v_readlane_b32 s43, v34, 0
  s_nop 0
  s_ashr_i32 s43, s43, 3
  s_add_u32 s43, s43, s62
  v_mov_b32 v32, s43
  ds_write_b32 v33, v32 offset:6208
L_c1_18:
  v_dot2c_f32_bf16_dpp v72, v56, v208 row_newbcast:12 row_mask:0xf bank_mask:0xf
  v_dot2c_f32_bf16_dpp v73, v64, v208 row_newbcast:12 row_mask:0xf bank_mask:0xf
  v_dot2c_f32_bf16_dpp v74, v56, v209 row_newbcast:12 row_mask:0xf bank_mask:0xf
  v_dot2c_f32_bf16_dpp v75, v64, v209 row_newbcast:12 row_mask:0xf bank_mask:0xf
  v_dot2c_f32_bf16_dpp v76, v56, v210 row_newbcast:12 row_mask:0xf bank_mask:0xf
  v_dot2c_f32_bf16_dpp v77, v64, v210 row_newbcast:12 row_mask:0xf bank_mask:0xf
  v_dot2c_f32_bf16_dpp v78, v56, v211 row_newbcast:12 row_mask:0xf bank_mask:0xf
  v_dot2c_f32_bf16_dpp v79, v64, v211 row_newbcast:12 row_mask:0xf bank_mask:0xf
  s_waitcnt vmcnt(2)
  s_cmp_gt_u32 s99, 4
  s_cbranch_scc1 L_v3_b3s4
  buffer_load_dwordx4 v[160:163], v2, s[8:11], s97 offen offset:0 nt
L_v3_b3s4:
  v_dot2c_f32_bf16_dpp v72, v56, v212 row_newbcast:13 row_mask:0xf bank_mask:0xf
  v_dot2c_f32_bf16_dpp v73, v64, v212 row_newbcast:13 row_mask:0xf bank_mask:0xf
  v_dot2c_f32_bf16_dpp v74, v56, v213 row_newbcast:13 row_mask:0xf bank_mask:0xf
  v_dot2c_f32_bf16_dpp v75, v64, v213 row_newbcast:13 row_mask:0xf bank_mask:0xf
  v_dot2c_f32_bf16_dpp v76, v56, v214 row_newbcast:13 row_mask:0xf bank_mask:0xf
  v_dot2c_f32_bf16_dpp v77, v64, v214 row_newbcast:13 row_mask:0xf bank_mask:0xf
  v_dot2c_f32_bf16_dpp v78, v56, v215 row_newbcast:13 row_mask:0xf bank_mask:0xf
  v_dot2c_f32_bf16_dpp v79, v64, v215 row_newbcast:13 row_mask:0xf bank_mask:0xf
  s_waitcnt vmcnt(2)
  s_cmp_gt_u32 s99, 5
  s_cbranch_scc1 L_v3_b3s5
  s_add_u32 s42, s97, 8192
  buffer_load_dwordx4 v[164:167], v2, s[8:11], s42 offen offset:0 nt
L_v3_b3s5:
  s_memrealtime s[94:95]
  ds_read_b32 v31, v33 offset:6208
  v_dot2c_f32_bf16_dpp v72, v56, v216 row_newbcast:14 row_mask:0xf bank_mask:0xf
  v_dot2c_f32_bf16_dpp v73, v64, v216 row_newbcast:14 row_mask:0xf bank_mask:0xf
  v_dot2c_f32_bf16_dpp v74, v56, v217 row_newbcast:14 row_mask:0xf bank_mask:0xf
  v_dot2c_f32_bf16_dpp v75, v64, v217 row_newbcast:14 row_mask:0xf bank_mask:0xf
  v_dot2c_f32_bf16_dpp v76, v56, v218 row_newbcast:14 row_mask:0xf bank_mask:0xf
  v_dot2c_f32_bf16_dpp v77, v64, v218 row_newbcast:14 row_mask:0xf bank_mask:0xf
  v_dot2c_f32_bf16_dpp v78, v56, v219 row_newbcast:14 row_mask:0xf bank_mask:0xf
  v_dot2c_f32_bf16_dpp v79, v64, v219 row_newbcast:14 row_mask:0xf bank_mask:0xf
  s_waitcnt vmcnt(2)
  s_add_u32 s42, s97, 16384
  buffer_load_dwordx4 v[168:171], v2, s[8:11], s42 offen offset:0 nt
  v_dot2c_f32_bf16_dpp v72, v56, v220 row_newbcast:15 row_mask:0xf bank_mask:0xf
  v_dot2c_f32_bf16_dpp v73, v64, v220 row_newbcast:15 row_mask:0xf bank_mask:0xf
  v_dot2c_f32_bf16_dpp v74, v56, v221 row_newbcast:15 row_mask:0xf bank_mask:0xf
  v_dot2c_f32_bf16_dpp v75, v64, v221 row_newbcast:15 row_mask:0xf bank_mask:0xf
  v_dot2c_f32_bf16_dpp v76, v56, v222 row_newbcast:15 row_mask:0xf bank_mask:0xf
  v_dot2c_f32_bf16_dpp v77, v64, v222 row_newbcast:15 row_mask:0xf bank_mask:0xf
  v_dot2c_f32_bf16_dpp v78, v56, v223 row_newbcast:15 row_mask:0xf bank_mask:0xf
  v_dot2c_f32_bf16_dpp v79, v64, v223 row_newbcast:15 row_mask:0xf bank_mask:0xf
  s_cmp_eq_u32 s40, 917504
  s_cbranch_scc1 L_v_done
  v_mov_b32 v56, v57
  v_mov_b32 v64, v65
  v_mov_b32 v57, v58
  v_mov_b32 v65, v66
  v_mov_b32 v58, v59
  v_mov_b32 v66, v67
  v_mov_b32 v59, v60
  v_mov_b32 v67, v68
  v_mov_b32 v60, v61
  v_mov_b32 v68, v69
  v_mov_b32 v61, v62
  v_mov_b32 v69, v70
  v_mov_b32 v62, v63
  v_mov_b32 v70, v71
  s_add_u32 s92, s92, 110
  s_waitcnt lgkmcnt(0)
  v_readfirstlane_b32 s63, v31
  s_sub_u32 s93, s94, s92
  s_sub_u32 s43, s63, s93
  s_cmp_eq_u32 s63, 0x80000000
  s_cselect_b32 s43, 0, s43
  s_cselect_b32 s96, s61, 3
  s_cmp_gt_i32 s43, s13
  s_cselect_b32 s96, 2, s96
  s_cmp_lt_i32 s43, s14
  s_cselect_b32 s96, 4, s96
  s_cmp_lt_i32 s43, s15
  s_cselect_b32 s96, 6, s96
  s_mov_b32 s99, 3
  s_branch L_v0_next
L_v3_b4:
  s_waitcnt vmcnt(3)
  s_cmp_gt_u32 s99, 4
  s_cbranch_scc1 L_v3_b4s4
  buffer_load_dwordx4 v[160:163], v2, s[8:11], s97 offen offset:0 nt
L_v3_b4s4:
  s_and_b32 s43, s98, 7
  s_cmp_lg_u32 s43, s3
  s_cbranch_scc1 L_c1_19
  v_subrev_u32 v34, s62, v34
  v_add_u32 v32, 0x1000, v34
  v_cmp_gt_u32 vcc, 0x2000, v32
  s_nop 1
  v_cndmask_b32 v34, 0, v34, vcc
  s_nop 1
  v_add_u32_dpp v34, v34, v34 row_ror:8 row_mask:0xf bank_mask:0xf
  s_nop 1
  v_add_u32_dpp v34, v34, v34 row_ror:4 row_mask:0xf bank_mask:0xf
  s_nop 1
  v_add_u32_dpp v34, v34, v34 row_ror:2 row_mask:0xf bank_mask:0xf
  s_nop 1
  v_add_u32_dpp v34, v34, v34 row_ror:1 row_mask:0xf bank_mask:0xf
  s_nop 0
  v_readlane_b32 s43, v34, 0
  s_nop 0
  s_ashr_i32 s43, s43, 3
  s_add_u32 s43, s43, s62
  v_mov_b32 v32, s43
  ds_write_b32 v33, v32 offset:6208
L_c1_19:
  v_dot2c_f32_bf16_dpp v72, v56, v208 row_newbcast:12 row_mask:0xf bank_mask:0xf
  v_dot2c_f32_bf16_dpp v73, v64, v208 row_newbcast:12 row_mask:0xf bank_mask:0xf
  v_dot2c_f32_bf16_dpp v74, v56, v209 row_newbcast:12 row_mask:0xf bank_mask:0xf
  v_dot2c_f32_bf16_dpp v75, v64, v209 row_newbcast:12 row_mask:0xf bank_mask:0xf
  v_dot2c_f32_bf16_dpp v76, v56, v210 row_newbcast:12 row_mask:0xf bank_mask:0xf
  v_dot2c_f32_bf16_dpp v77, v64, v210 row_newbcast:12 row_mask:0xf bank_mask:0xf
  v_dot2c_f32_bf16_dpp v78, v56, v211 row_newbcast:12 row_mask:0xf bank_mask:0xf
  v_dot2c_f32_bf16_dpp v79, v64, v211 row_newbcast:12 row_mask:0xf bank_mask:0xf
  s_waitcnt vmcnt(3)
  s_cmp_gt_u32 s99, 5
  s_cbranch_scc1 L_v3_b4s5
  s_add_u32 s42, s97, 8192
  buffer_load_dwordx4 v[164:167], v2, s[8:11], s42 offen offset:0 nt
L_v3_b4s5:
  v_dot2c_f32_bf16_dpp v72, v56, v212 row_newbcast:13 row_mask:0xf bank_mask:0xf
  v_dot2c_f32_bf16_dpp v73, v64, v212 row_newbcast:13 row_mask:0xf bank_mask:0xf
  v_dot2c_f32_bf16_dpp v74, v56, v213 row_newbcast:13 row_mask:0xf bank_mask:0xf
  v_dot2c_f32_bf16_dpp v75, v64, v213 row_newbcast:13 row_mask:0xf bank_mask:0xf
  v_dot2c_f32_bf16_dpp v76, v56, v214 row_newbcast:13 row_mask:0xf bank_mask:0xf
  v_dot2c_f32_bf16_dpp v77, v64, v214 row_newbcast:13 row_mask:0xf bank_mask:0xf
  v_dot2c_f32_bf16_dpp v78, v56, v215 row_newbcast:13 row_mask:0xf bank_mask:0xf
  v_dot2c_f32_bf16_dpp v79, v64, v215 row_newbcast:13 row_mask:0xf bank_mask:0xf
  s_waitcnt vmcnt(3)
  s_add_u32 s42, s97, 16384
  buffer_load_dwordx4 v[168:171], v2, s[8:11], s42 offen offset:0 nt
  s_memrealtime s[94:95]
  ds_read_b32 v31, v33 offset:6208
  v_dot2c_f32_bf16_dpp v72, v56, v216 row_newbcast:14 row_mask:0xf bank_mask:0xf
  v_dot2c_f32_bf16_dpp v73, v64, v216 row_newbcast:14 row_mask:0xf bank_mask:0xf
  v_dot2c_f32_bf16_dpp v74, v56, v217 row_newbcast:14 row_mask:0xf bank_mask:0xf
  v_dot2c_f32_bf16_dpp v75, v64, v217 row_newbcast:14 row_mask:0xf bank_mask:0xf
  v_dot2c_f32_bf16_dpp v76, v56, v218 row_newbcast:14 row_mask:0xf bank_mask:0xf
  v_dot2c_f32_bf16_dpp v77, v64, v218 row_newbcast:14 row_mask:0xf bank_mask:0xf
  v_dot2c_f32_bf16_dpp v78, v56, v219 row_newbcast:14 row_mask:0xf bank_mask:0xf
  v_dot2c_f32_bf16_dpp v79, v64, v219 row_newbcast:14 row_mask:0xf bank_mask:0xf
  s_waitcnt vmcnt(3)
  s_add_u32 s42, s97, 24576
  buffer_load_dwordx4 v[172:175], v2, s[8:11], s42 offen offset:0 nt
  v_dot2c_f32_bf16_dpp v72, v56, v220 row_newbcast:15 row_mask:0xf bank_mask:0xf
  v_dot2c_f32_bf16_dpp v73, v64, v220 row_newbcast:15 row_mask:0xf bank_mask:0xf
  v_dot2c_f32_bf16_dpp v74, v56, v221 row_newbcast:15 row_mask:0xf bank_mask:0xf
  v_dot2c_f32_bf16_dpp v75, v64, v221 row_newbcast:15 row_mask:0xf bank_mask:0xf
  v_dot2c_f32_bf16_dpp v76, v56, v222 row_newbcast:15 row_mask:0xf bank_mask:0xf
  v_dot2c_f32_bf16_dpp v77, v64, v222 row_newbcast:15 row_mask:0xf bank_mask:0xf
  v_dot2c_f32_bf16_dpp v78, v56, v223 row_newbcast:15 row_mask:0xf bank_mask:0xf
  v_dot2c_f32_bf16_dpp v79, v64, v223 row_newbcast:15 row_mask:0xf bank_mask:0xf
  s_cmp_eq_u32 s40, 917504
  s_cbranch_scc1 L_v_done
  v_mov_b32 v56, v57
  v_mov_b32 v64, v65
  v_mov_b32 v57, v58
  v_mov_b32 v65, v66
  v_mov_b32 v58, v59
  v_mov_b32 v66, v67
  v_mov_b32 v59, v60
  v_mov_b32 v67, v68
  v_mov_b32 v60, v61
  v_mov_b32 v68, v69
  v_mov_b32 v61, v62
  v_mov_b32 v69, v70
  v_mov_b32 v62, v63
  v_mov_b32 v70, v71
  s_add_u32 s92, s92, 110
  s_waitcnt lgkmcnt(0)
  v_readfirstlane_b32 s63, v31
  s_sub_u32 s93, s94, s92
  s_sub_u32 s43, s63, s93
  s_cmp_eq_u32 s63, 0x80000000
  s_cselect_b32 s43, 0, s43
  s_cselect_b32 s96, s61, 3
  s_cmp_gt_i32 s43, s13
  s_cselect_b32 s96, 2, s96
  s_cmp_lt_i32 s43, s14
  s_cselect_b32 s96, 4, s96
  s_cmp_lt_i32 s43, s15
  s_cselect_b32 s96, 6, s96
  s_mov_b32 s99, 4
  s_branch L_v0_next
L_v3_b6:
  s_waitcnt vmcnt(5)
  s_add_u32 s42, s97, 16384
  buffer_load_dwordx4 v[168:171], v2, s[8:11], s42 offen offset:0 nt
  s_and_b32 s43, s98, 7
  s_cmp_lg_u32 s43, s3
  s_cbranch_scc1 L_c1_20
  v_subrev_u32 v34, s62, v34
  v_add_u32 v32, 0x1000, v34
  v_cmp_gt_u32 vcc, 0x2000, v32
  s_nop 1
  v_cndmask_b32 v34, 0, v34, vcc
  s_nop 1
  v_add_u32_dpp v34, v34, v34 row_ror:8 row_mask:0xf bank_mask:0xf
  s_nop 1
  v_add_u32_dpp v34, v34, v34 row_ror:4 row_mask:0xf bank_mask:0xf
  s_nop 1
  v_add_u32_dpp v34, v34, v34 row_ror:2 row_mask:0xf bank_mask:0xf
  s_nop 1
  v_add_u32_dpp v34, v34, v34 row_ror:1 row_mask:0xf bank_mask:0xf
  s_nop 0
  v_readlane_b32 s43, v34, 0
  s_nop 0
  s_ashr_i32 s43, s43, 3
  s_add_u32 s43, s43, s62
  v_mov_b32 v32, s43
  ds_write_b32 v33, v32 offset:6208
L_c1_20:
  v_dot2c_f32_bf16_dpp v72, v56, v208 row_newbcast:12 row_mask:0xf bank_mask:0xf
  v_dot2c_f32_bf16_dpp v73, v64, v208 row_newbcast:12 row_mask:0xf bank_mask:0xf
  v_dot2c_f32_bf16_dpp v74, v56, v209 row_newbcast:12 row_mask:0xf bank_mask:0xf
  v_dot2c_f32_bf16_dpp v75, v64, v209 row_newbcast:12 row_mask:0xf bank_mask:0xf
  v_dot2c_f32_bf16_dpp v76, v56, v210 row_newbcast:12 row_mask:0xf bank_mask:0xf
  v_dot2c_f32_bf16_dpp v77, v64, v210 row_newbcast:12 row_mask:0xf bank_mask:0xf
  v_dot2c_f32_bf16_dpp v78, v56, v211 row_newbcast:12 row_mask:0xf bank_mask:0xf
  v_dot2c_f32_bf16_dpp v79, v64, v211 row_newbcast:12 row_mask:0xf bank_mask:0xf
  s_waitcnt vmcnt(5)
  s_add_u32 s42, s97, 24576
  buffer_load_dwordx4 v[172:175], v2, s[8:11], s42 offen offset:0 nt
  v_dot2c_f32_bf16_dpp v72, v56, v212 row_newbcast:13 row_mask:0xf bank_mask:0xf
  v_dot2c_f32_bf16_dpp v73, v64, v212 row_newbcast:13 row_mask:0xf bank_mask:0xf
  v_dot2c_f32_bf16_dpp v74, v56, v213 row_newbcast:13 row_mask:0xf bank_mask:0xf
  v_dot2c_f32_bf16_dpp v75, v64, v213 row_newbcast:13 row_mask:0xf bank_mask:0xf
  v_dot2c_f32_bf16_dpp v76, v56, v214 row_newbcast:13 row_mask:0xf bank_mask:0xf
  v_dot2c_f32_bf16_dpp v77, v64, v214 row_newbcast:13 row_mask:0xf bank_mask:0xf
  v_dot2c_f32_bf16_dpp v78, v56, v215 row_newbcast:13 row_mask:0xf bank_mask:0xf
  v_dot2c_f32_bf16_dpp v79, v64, v215 row_newbcast:13 row_mask:0xf bank_mask:0xf
  s_waitcnt vmcnt(5)
  s_add_u32 s42, s97, 32768
  buffer_load_dwordx4 v[176:179], v2, s[8:11], s42 offen offset:0 nt
  s_memrealtime s[94:95]
  ds_read_b32 v31, v33 offset:6208
  v_dot2c_f32_bf16_dpp v72, v56, v216 row_newbcast:14 row_mask:0xf bank_mask:0xf
  v_dot2c_f32_bf16_dpp v73, v64, v216 row_newbcast:14 row_mask:0xf bank_mask:0xf
  v_dot2c_f32_bf16_dpp v74, v56, v217 row_newbcast:14 row_mask:0xf bank_mask:0xf
  v_dot2c_f32_bf16_dpp v75, v64, v217 row_newbcast:14 row_mask:0xf bank_mask:0xf
  v_dot2c_f32_bf16_dpp v76, v56, v218 row_newbcast:14 row_mask:0xf bank_mask:0xf
  v_dot2c_f32_bf16_dpp v77, v64, v218 row_newbcast:14 row_mask:0xf bank_mask:0xf
  v_dot2c_f32_bf16_dpp v78, v56, v219 row_newbcast:14 row_mask:0xf bank_mask:0xf
  v_dot2c_f32_bf16_dpp v79, v64, v219 row_newbcast:14 row_mask:0xf bank_mask:0xf
  s_waitcnt vmcnt(5)
  s_add_u32 s42, s97, 40960
  buffer_load_dwordx4 v[180:183], v2, s[8:11], s42 offen offset:0 nt
  v_dot2c_f32_bf16_dpp v72, v56, v220 row_newbcast:15 row_mask:0xf bank_mask:0xf
  v_dot2c_f32_bf16_dpp v73, v64, v220 row_newbcast:15 row_mask:0xf bank_mask:0xf
  v_dot2c_f32_bf16_dpp v74, v56, v221 row_newbcast:15 row_mask:0xf bank_mask:0xf
  v_dot2c_f32_bf16_dpp v75, v64, v221 row_newbcast:15 row_mask:0xf bank_mask:0xf
  v_dot2c_f32_bf16_dpp v76, v56, v222 row_newbcast:15 row_mask:0xf bank_mask:0xf
  v_dot2c_f32_bf16_dpp v77, v64, v222 row_newbcast:15 row_mask:0xf bank_mask:0xf
  v_dot2c_f32_bf16_dpp v78, v56, v223 row_newbcast:15 row_mask:0xf bank_mask:0xf
  v_dot2c_f32_bf16_dpp v79, v64, v223 row_newbcast:15 row_mask:0xf bank_mask:0xf
  s_cmp_eq_u32 s40, 917504
  s_cbranch_scc1 L_v_done
  v_mov_b32 v56, v57
  v_mov_b32 v64, v65
  v_mov_b32 v57, v58
  v_mov_b32 v65, v66
  v_mov_b32 v58, v59
  v_mov_b32 v66, v67
  v_mov_b32 v59, v60
  v_mov_b32 v67, v68
  v_mov_b32 v60, v61
  v_mov_b32 v68, v69
  v_mov_b32 v61, v62
  v_mov_b32 v69, v70
  v_mov_b32 v62, v63
  v_mov_b32 v70, v71
  s_add_u32 s92, s92, 110
  s_waitcnt lgkmcnt(0)
  v_readfirstlane_b32 s63, v31
  s_sub_u32 s93, s94, s92
  s_sub_u32 s43, s63, s93
  s_cmp_eq_u32 s63, 0x80000000
  s_cselect_b32 s43, 0, s43
  s_cselect_b32 s96, s61, 3
  s_cmp_gt_i32 s43, s13
  s_cselect_b32 s96, 2, s96
  s_cmp_lt_i32 s43, s14
  s_cselect_b32 s96, 4, s96
  s_cmp_lt_i32 s43, s15
  s_cselect_b32 s96, 6, s96
  s_mov_b32 s99, 6
  s_branch L_v0_next
L_v_done:
  v_mov_b32 v242, 1
  v_permlane32_swap_b32 v72, v76
  v_permlane32_swap_b32 v73, v77
  v_permlane32_swap_b32 v74, v78
  v_permlane32_swap_b32 v75, v79
  v_add_f32 v72, v72, v76
  v_add_f32 v73, v73, v77
  v_add_f32 v74, v74, v78
  v_add_f32 v75, v75, v79
  s_nop 0
  v_permlane16_swap_b32 v72, v74
  v_permlane16_swap_b32 v73, v75
  v_add_f32 v72, v72, v74
  v_add_f32 v73, v73, v75
  ds_write_b64 v246, v[72:73] offset:0
  s_mov_b64 exec, 1
  ds_add_rtn_u32 v242, v33, v242 offset:6252
  s_mov_b64 exec, -1
  ds_read_b32 v241, v33 offset:6244
  ds_read_b64 v[224:225], v247 offset:0
  ds_read_b64 v[226:227], v247 offset:512
  ds_read_b64 v[228:229], v247 offset:1024
  ds_read_b64 v[230:231], v247 offset:1536
  ds_read_b64 v[232:233], v247 offset:2048
  ds_read_b64 v[234:235], v247 offset:2560
  ds_read_b64 v[236:237], v247 offset:3072
  ds_read_b64 v[238:239], v247 offset:3584
  s_waitcnt lgkmcnt(9)
  v_readfirstlane_b32 s42, v242
  s_nop 0
  s_cmp_lg_u32 s42, 7
  s_cbranch_scc1 L_o_done
  s_waitcnt lgkmcnt(6)
  v_pk_add_f32 v[224:225], v[224:225], v[226:227]
  s_waitcnt lgkmcnt(5)
  v_pk_add_f32 v[224:225], v[224:225], v[228:229]
  s_waitcnt lgkmcnt(4)
  v_pk_add_f32 v[224:225], v[224:225], v[230:231]
  s_waitcnt lgkmcnt(3)
  v_pk_add_f32 v[224:225], v[224:225], v[232:233]
  s_waitcnt lgkmcnt(2)
  v_pk_add_f32 v[224:225], v[224:225], v[234:235]
  s_waitcnt lgkmcnt(1)
  v_pk_add_f32 v[224:225], v[224:225], v[236:237]
  s_waitcnt lgkmcnt(0)
  v_pk_add_f32 v[224:225], v[224:225], v[238:239]
  v_cvt_pk_bf16_f32 v8, v224, v225
  v_cmp_ne_u32 vcc, 0, v241
  s_cbranch_vccnz L_rs0
L_rs0b:
  v_min_u32 v8, -2, v8
  buffer_store_dword v8, v248, s[24:27], 0 offen sc1
L_o_done:
  s_barrier
  ds_read_b32 v241, v33 offset:6244
  s_waitcnt lgkmcnt(0)
  v_cmp_ne_u32 vcc, 0, v241
  s_cbranch_vccnz L_rs1
L_o_dn2:
  s_cmp_ge_u32 s90, s49
  s_cbranch_scc1 L_ld
  s_mov_b32 s22, s60
  s_lshl_b32 s47, s90, 10
  s_add_u32 m0, s47, s91
  s_mul_i32 s47, s90, s46
  buffer_load_dwordx4 v39, s[20:23], s47 offen  lds
  s_add_u32 s90, s90, 1
  s_cmp_ge_u32 s90, s49
  s_cbranch_scc1 L_ld
  s_lshl_b32 s47, s90, 10
  s_add_u32 m0, s47, s91
  s_mul_i32 s47, s90, s46
  buffer_load_dwordx4 v39, s[20:23], s47 offen  lds
  s_add_u32 s90, s90, 1
  s_cmp_ge_u32 s90, s49
  s_cbranch_scc1 L_ld
  s_lshl_b32 s47, s90, 10
  s_add_u32 m0, s47, s91
  s_mul_i32 s47, s90, s46
  buffer_load_dwordx4 v39, s[20:23], s47 offen  lds
  s_add_u32 s90, s90, 1
  s_cmp_ge_u32 s90, s49
  s_cbranch_scc1 L_ld
  s_lshl_b32 s47, s90, 10
  s_add_u32 m0, s47, s91
  s_mul_i32 s47, s90, s46
  buffer_load_dwordx4 v39, s[20:23], s47 offen  lds
  s_add_u32 s90, s90, 1
  s_cmp_ge_u32 s90, s49
  s_cbranch_scc1 L_ld
  s_lshl_b32 s47, s90, 10
  s_add_u32 m0, s47, s91
  s_mul_i32 s47, s90, s46
  buffer_load_dwordx4 v39, s[20:23], s47 offen  lds
  s_add_u32 s90, s90, 1
  s_cmp_ge_u32 s90, s49
  s_cbranch_scc1 L_ld
  s_lshl_b32 s47, s90, 10
  s_add_u32 m0, s47, s91
  s_mul_i32 s47, s90, s46
  buffer_load_dwordx4 v39, s[20:23], s47 offen  lds
  s_add_u32 s90, s90, 1
  s_cmp_ge_u32 s90, s49
  s_cbranch_scc1 L_ld
  s_lshl_b32 s47, s90, 10
  s_add_u32 m0, s47, s91
  s_mul_i32 s47, s90, s46
  buffer_load_dwordx4 v39, s[20:23], s47 offen  lds
  s_add_u32 s90, s90, 1
  s_cmp_ge_u32 s90, s49
  s_cbranch_scc1 L_ld
  s_lshl_b32 s47, s90, 10
  s_add_u32 m0, s47, s91
  s_mul_i32 s47, s90, s46
  buffer_load_dwordx4 v39, s[20:23], s47 offen  lds
  s_add_u32 s90, s90, 1
  s_cmp_ge_u32 s90, s49
  s_cbranch_scc1 L_ld
  s_lshl_b32 s47, s90, 10
  s_add_u32 m0, s47, s91
  s_mul_i32 s47, s90, s46
  buffer_load_dwordx4 v39, s[20:23], s47 offen  lds
  s_add_u32 s90, s90, 1
  s_cmp_ge_u32 s90, s49
  s_cbranch_scc1 L_ld
  s_lshl_b32 s47, s90, 10
  s_add_u32 m0, s47, s91
  s_mul_i32 s47, s90, s46
  buffer_load_dwordx4 v39, s[20:23], s47 offen  lds
  s_add_u32 s90, s90, 1
L_ld:
  s_cmp_le_u32 s44, 0
  s_cbranch_scc1 L_fin
  s_mov_b32 s41, 0
  v_mov_b32 v244, 0
L_rdy:
  v_readfirstlane_b32 s42, v251
  s_nop 0
  s_cmp_ge_u32 s42, 256
  s_cbranch_scc1 L_rdy_ok
  s_add_u32 s41, s41, 1
  s_cmp_gt_u32 s41, 400000
  s_cbranch_scc1 L_rdy_ok
  global_load_dword v251, v244, s[84:85] sc1
  s_waitcnt vmcnt(0)
  s_branch L_rdy
L_rdy_ok:
  v_bfe_u32 v244, v0, 4, 2
  v_and_b32 v245, 7, v0
  s_lshl_b32 s42, s3, 11
  v_add_u32 v243, s42, v250
  s_mov_b32 s62, 0x00ff00ff
  s_mov_b32 s63, 0x00ff00ff
  v_mov_b32 v70, 0
  v_mov_b32 v71, 1
  s_cmp_eq_u32 s44, 2
  s_cbranch_scc1 L_ffn
  s_cmp_eq_u32 s44, 3
  s_cbranch_scc1 L_down
  v_lshlrev_b32 v224, 13, v245
  v_lshl_add_u32 v224, v244, 4, v224
  s_lshl_b32 s40, s57, 1
  v_and_b32 v240, 0x37, v1
  v_lshlrev_b32 v240, 4, v240
  v_bfe_u32 v239, v0, 3, 1
  v_lshl_add_u32 v240, v239, 10, v240
  v_bfe_u32 v238, v0, 1, 3
  v_lshlrev_b32 v224, 13, v238
  v_lshl_add_u32 v224, v244, 5, v224
  v_and_b32 v237, 1, v0
  v_lshl_add_u32 v224, v237, 4, v224
  v_lshl_add_u32 v243, v244, 4, v238
  s_lshl_b32 s42, s3, 11
  v_lshl_add_u32 v243, v243, 4, s42
  s_mov_b32 s62, 0x55555555
  s_mov_b32 s63, 0x55555555
  s_mov_b32 s41, 0
  buffer_load_dwordx4 v[160:163], v224, s[24:27], s40 offen offset:0 sc1
  buffer_load_dwordx4 v[164:167], v224, s[24:27], s40 offen offset:128 sc1
  s_waitcnt vmcnt(2)
  ds_read_b64_tr_b16 v[80:81], v124 offset:0
  ds_read_b64_tr_b16 v[82:83], v124 offset:256
  ds_read_b64_tr_b16 v[84:85], v124 offset:32
  ds_read_b64_tr_b16 v[86:87], v124 offset:288
  ds_read_b64_tr_b16 v[88:89], v124 offset:512
  ds_read_b64_tr_b16 v[90:91], v124 offset:768
  ds_read_b64_tr_b16 v[92:93], v124 offset:544
  ds_read_b64_tr_b16 v[94:95], v124 offset:800
  ds_read_b64_tr_b16 v[96:97], v124 offset:4096
  ds_read_b64_tr_b16 v[98:99], v124 offset:4352
  ds_read_b64_tr_b16 v[100:101], v124 offset:4128
  ds_read_b64_tr_b16 v[102:103], v124 offset:4384
  ds_read_b64_tr_b16 v[104:105], v124 offset:4608
  ds_read_b64_tr_b16 v[106:107], v124 offset:4864
  ds_read_b64_tr_b16 v[108:109], v124 offset:4640
  ds_read_b64_tr_b16 v[110:111], v124 offset:4896
  s_waitcnt lgkmcnt(0)
  s_branch L_wo_chk
L_wo_rt:
  v_cmp_eq_u32 vcc, -1, v56
  s_nop 0
  s_mov_b64 exec, vcc
  s_cbranch_execz L_wo_s0
  buffer_load_dwordx4 v[160:163], v224, s[24:27], s40 offen offset:0 sc1
  buffer_load_dwordx4 v[164:167], v224, s[24:27], s40 offen offset:128 sc1
L_wo_s0:
  s_mov_b64 exec, -1
  s_add_u32 s41, s41, 1
  s_cmp_gt_u32 s41, 400000
  s_cbranch_scc1 L_wo_to
L_wo_chk:
  s_waitcnt vmcnt(0)
  v_mfma_f32_16x16x32_bf16 v[72:75], v[80:83], v[160:163], 0
  v_max_u32 v56, v160, v161
  v_max3_u32 v56, v56, v162, v163
  v_mfma_f32_16x16x32_bf16 v[8:11], v[88:91], v[160:163], 0
  v_max3_u32 v56, v56, v164, v165
  v_max3_u32 v56, v56, v166, v167
  v_mfma_f32_16x16x32_bf16 v[76:79], v[84:87], v[160:163], 0
  v_cmp_eq_u32 vcc, -1, v56
  s_cbranch_vccnz L_wo_rt
L_wo_ok:
  s_waitcnt lgkmcnt(0)
  v_mfma_f32_16x16x32_bf16 v[12:15], v[92:95], v[160:163], 0
  v_mfma_f32_16x16x32_bf16 v[72:75], v[96:99], v[164:167], v[72:75]
  v_mfma_f32_16x16x32_bf16 v[8:11], v[104:107], v[164:167], v[8:11]
  v_mfma_f32_16x16x32_bf16 v[76:79], v[100:103], v[164:167], v[76:79]
  v_mfma_f32_16x16x32_bf16 v[12:15], v[108:111], v[164:167], v[12:15]
  s_nop 5
  v_add_f32_dpp v72, v8, v72 quad_perm:[1,1,3,3] row_mask:0xf bank_mask:0xf
  v_add_f32_dpp v73, v9, v73 quad_perm:[1,1,3,3] row_mask:0xf bank_mask:0xf
  v_add_f32_dpp v74, v10, v74 quad_perm:[1,1,3,3] row_mask:0xf bank_mask:0xf
  v_add_f32_dpp v75, v11, v75 quad_perm:[1,1,3,3] row_mask:0xf bank_mask:0xf
  v_add_f32_dpp v76, v12, v76 quad_perm:[1,1,3,3] row_mask:0xf bank_mask:0xf
  v_add_f32_dpp v77, v13, v77 quad_perm:[1,1,3,3] row_mask:0xf bank_mask:0xf
  v_add_f32_dpp v78, v14, v78 quad_perm:[1,1,3,3] row_mask:0xf bank_mask:0xf
  v_add_f32_dpp v79, v15, v79 quad_perm:[1,1,3,3] row_mask:0xf bank_mask:0xf
  s_mov_b64 exec, s[62:63]
  ds_write_b128 v243, v[72:75] offset:16384
  ds_write_b128 v243, v[76:79] offset:17408
  s_mov_b64 exec, 1
  ds_add_rtn_u32 v242, v70, v71 offset:6248
  s_mov_b64 exec, -1
  ds_read_b128 v[8:11], v240 offset:16384
  ds_read_b128 v[12:15], v240 offset:18432
  ds_read_b128 v[16:19], v240 offset:20480
  ds_read_b128 v[20:23], v240 offset:22528
  ds_read_b128 v[24:27], v240 offset:24576
  ds_read_b128 v[28:31], v240 offset:26624
  ds_read_b128 v[32:35], v240 offset:28672
  ds_read_b128 v[36:39], v240 offset:30720
  s_waitcnt lgkmcnt(8)
  v_readfirstlane_b32 s42, v242
  s_nop 0
  s_cmp_lg_u32 s42, 7
  s_cbranch_scc1 L_fin
  s_waitcnt lgkmcnt(6)
  v_pk_add_f32 v[8:9], v[8:9], v[12:13]
  v_pk_add_f32 v[10:11], v[10:11], v[14:15]
  s_waitcnt lgkmcnt(5)
  v_pk_add_f32 v[8:9], v[8:9], v[16:17]
  v_pk_add_f32 v[10:11], v[10:11], v[18:19]
  s_waitcnt lgkmcnt(4)
  v_pk_add_f32 v[8:9], v[8:9], v[20:21]
  v_pk_add_f32 v[10:11], v[10:11], v[22:23]
  s_waitcnt lgkmcnt(3)
  v_pk_add_f32 v[8:9], v[8:9], v[24:25]
  v_pk_add_f32 v[10:11], v[10:11], v[26:27]
  s_waitcnt lgkmcnt(2)
  v_pk_add_f32 v[8:9], v[8:9], v[28:29]
  v_pk_add_f32 v[10:11], v[10:11], v[30:31]
  s_waitcnt lgkmcnt(1)
  v_pk_add_f32 v[8:9], v[8:9], v[32:33]
  v_pk_add_f32 v[10:11], v[10:11], v[34:35]
  s_waitcnt lgkmcnt(0)
  v_pk_add_f32 v[8:9], v[8:9], v[36:37]
  v_pk_add_f32 v[10:11], v[10:11], v[38:39]
  v_min_u32 v8, -2, v8
  v_min_u32 v9, -2, v9
  v_min_u32 v10, -2, v10
  v_min_u32 v11, -2, v11
  buffer_store_dwordx4 v[8:11], v249, s[24:27], 0 offen sc1
  s_branch L_fin
L_ffn:
  s_cmp_lt_u32 s3, 4
  s_cbranch_scc1 L_f_row
  v_bfe_u32 v226, v0, 2, 2
  v_lshl_add_u32 v227, v244, 3, v226
  v_lshlrev_b32 v227, 6, v227
  v_and_b32 v228, 1, v0
  v_mul_u32_u24 v228, 10240, v228
  v_add_u32 v227, v227, v228
  v_bfe_u32 v228, v0, 1, 1
  v_lshl_add_u32 v227, v228, 3, v227
  v_and_b32 v228, 1, v0
  v_bfe_u32 v229, v0, 4, 1
  v_lshl_or_b32 v228, v228, 1, v229
  s_and_b32 s42, s3, 3
  v_xor_b32 v228, s42, v228
  v_lshl_add_u32 v227, v228, 4, v227
  v_add_u32 v227, 32768, v227
  v_add_u32 v228, 40960, v227
  v_and_b32 v229, 3, v0
  v_xor_b32 v230, v229, v244
  v_lshlrev_b32 v230, 4, v230
  v_lshl_add_u32 v230, v226, 6, v230
  v_lshl_add_u32 v241, v244, 8, v230
  v_lshlrev_b32 v234, 3, v229
  v_lshlrev_b32 v240, 4, v229
  v_lshl_add_u32 v240, v244, 2, v240
  v_lshl_add_u32 v240, v226, 1, v240
  s_lshl_b32 s42, s3, 6
  s_add_u32 s42, s42, s56
  s_sub_u32 s42, s42, 256
  v_add_u32 v240, s42, v240
  v_and_b32 v239, 0x14, v0
  v_cmp_eq_u32 vcc, 0, v239
  v_mov_b32 v239, 2147483632
  s_nop 0
  v_cndmask_b32 v240, v239, v240, vcc
  s_mov_b32 s57, 0xbdd2d3e8
  v_mov_b32 v238, 0xc0135761
  s_waitcnt vmcnt(0)
  v_mov_b32 v252, 0
  v_mov_b32 v253, 1
  s_mov_b64 exec, 1
  ds_add_u32 v252, v253 offset:6248
  s_mov_b64 exec, -1
L_f5w:
  ds_read_b32 v253, v252 offset:6248
  s_waitcnt lgkmcnt(0)
  v_cmp_gt_u32 vcc, 8, v253
  s_cbranch_vccnz L_f5w
  ds_read_b64_tr_b16 v[80:81], v227 offset:0
  ds_read_b64_tr_b16 v[82:83], v227 offset:256
  ds_read_b64_tr_b16 v[84:85], v227 offset:2048
  ds_read_b64_tr_b16 v[86:87], v227 offset:2304
  ds_read_b64_tr_b16 v[88:89], v227 offset:4096
  ds_read_b64_tr_b16 v[90:91], v227 offset:4352
  ds_read_b64_tr_b16 v[92:93], v227 offset:6144
  ds_read_b64_tr_b16 v[94:95], v227 offset:6400
  ds_read_b64_tr_b16 v[96:97], v227 offset:8192
  ds_read_b64_tr_b16 v[98:99], v227 offset:8448
  ds_read_b64_tr_b16 v[100:101], v227 offset:20480
  ds_read_b64_tr_b16 v[102:103], v227 offset:20736
  ds_read_b64_tr_b16 v[104:105], v227 offset:22528
  ds_read_b64_tr_b16 v[106:107], v227 offset:22784
  s_waitcnt lgkmcnt(12)
  ds_read_b64_tr_b16 v[108:109], v227 offset:24576
  ds_read_b64_tr_b16 v[110:111], v227 offset:24832
  s_waitcnt lgkmcnt(12)
  ds_read_b64_tr_b16 v[112:113], v227 offset:26624
  ds_read_b64_tr_b16 v[114:115], v227 offset:26880
  s_waitcnt lgkmcnt(12)
  ds_read_b64_tr_b16 v[116:117], v227 offset:28672
  ds_read_b64_tr_b16 v[118:119], v227 offset:28928
  s_waitcnt lgkmcnt(12)
  ds_read_b64_tr_b16 v[120:121], v228 offset:0
  ds_read_b64_tr_b16 v[122:123], v228 offset:256
  s_waitcnt lgkmcnt(12)
  ds_read_b64_tr_b16 v[124:125], v228 offset:2048
  ds_read_b64_tr_b16 v[126:127], v228 offset:2304
  s_waitcnt lgkmcnt(12)
  ds_read_b64_tr_b16 v[128:129], v228 offset:4096
  ds_read_b64_tr_b16 v[130:131], v228 offset:4352
  s_waitcnt lgkmcnt(12)
  ds_read_b64_tr_b16 v[132:133], v228 offset:6144
  ds_read_b64_tr_b16 v[134:135], v228 offset:6400
  s_waitcnt lgkmcnt(12)
  ds_read_b64_tr_b16 v[136:137], v228 offset:8192
  ds_read_b64_tr_b16 v[138:139], v228 offset:8448
  s_waitcnt lgkmcnt(12)
  ds_read_b64_tr_b16 v[140:141], v228 offset:20480
  ds_read_b64_tr_b16 v[142:143], v228 offset:20736
  s_waitcnt lgkmcnt(12)
  ds_read_b64_tr_b16 v[144:145], v228 offset:22528
  ds_read_b64_tr_b16 v[146:147], v228 offset:22784
  s_waitcnt lgkmcnt(12)
  ds_read_b64_tr_b16 v[148:149], v228 offset:24576
  ds_read_b64_tr_b16 v[150:151], v228 offset:24832
  s_waitcnt lgkmcnt(12)
  ds_read_b64_tr_b16 v[152:153], v228 offset:26624
  ds_read_b64_tr_b16 v[154:155], v228 offset:26880
  s_waitcnt lgkmcnt(12)
  ds_read_b64_tr_b16 v[156:157], v228 offset:28672
  ds_read_b64_tr_b16 v[158:159], v228 offset:28928
  s_waitcnt lgkmcnt(12)
  s_waitcnt lgkmcnt(10)
  s_waitcnt lgkmcnt(8)
  s_waitcnt lgkmcnt(6)
  s_waitcnt lgkmcnt(4)
  s_waitcnt lgkmcnt(2)
  s_waitcnt lgkmcnt(0)
  s_barrier
  ds_read_b128 v[8:11], v241 offset:8192
  ds_read_b128 v[12:15], v241 offset:9216
  ds_read_b128 v[16:19], v241 offset:10240
  ds_read_b128 v[20:23], v241 offset:11264
  ds_read_b128 v[24:27], v241 offset:12288
  s_waitcnt lgkmcnt(4)
  v_mfma_f32_16x16x32_bf16 v[40:43], v[80:83], v[8:11], 0
  v_mfma_f32_16x16x32_bf16 v[44:47], v[84:87], v[8:11], 0
  v_mfma_f32_16x16x32_bf16 v[48:51], v[88:91], v[8:11], 0
  v_mfma_f32_16x16x32_bf16 v[52:55], v[92:95], v[8:11], 0
  s_waitcnt lgkmcnt(3)
  v_mfma_f32_16x16x32_bf16 v[40:43], v[96:99], v[12:15], v[40:43]
  v_mfma_f32_16x16x32_bf16 v[44:47], v[100:103], v[12:15], v[44:47]
  v_mfma_f32_16x16x32_bf16 v[48:51], v[104:107], v[12:15], v[48:51]
  v_mfma_f32_16x16x32_bf16 v[52:55], v[108:111], v[12:15], v[52:55]
  s_waitcnt lgkmcnt(2)
  v_mfma_f32_16x16x32_bf16 v[40:43], v[112:115], v[16:19], v[40:43]
  v_mfma_f32_16x16x32_bf16 v[44:47], v[116:119], v[16:19], v[44:47]
  v_mfma_f32_16x16x32_bf16 v[48:51], v[120:123], v[16:19], v[48:51]
  v_mfma_f32_16x16x32_bf16 v[52:55], v[124:127], v[16:19], v[52:55]
  s_waitcnt lgkmcnt(1)
  v_mfma_f32_16x16x32_bf16 v[40:43], v[128:131], v[20:23], v[40:43]
  v_mfma_f32_16x16x32_bf16 v[44:47], v[132:135], v[20:23], v[44:47]
  v_mfma_f32_16x16x32_bf16 v[48:51], v[136:139], v[20:23], v[48:51]
  v_mfma_f32_16x16x32_bf16 v[52:55], v[140:143], v[20:23], v[52:55]
  s_waitcnt lgkmcnt(0)
  v_mfma_f32_16x16x32_bf16 v[40:43], v[144:147], v[24:27], v[40:43]
  v_mfma_f32_16x16x32_bf16 v[44:47], v[148:151], v[24:27], v[44:47]
  v_mfma_f32_16x16x32_bf16 v[48:51], v[152:155], v[24:27], v[48:51]
  v_mfma_f32_16x16x32_bf16 v[52:55], v[156:159], v[24:27], v[52:55]
  s_nop 5
  v_add_f32_dpp v56, v44, v40 row_ror:12 row_mask:0xf bank_mask:0x1
  v_add_f32_dpp v58, v46, v42 row_ror:12 row_mask:0xf bank_mask:0x1
  v_add_f32_dpp v57, v49, v45 row_ror:12 row_mask:0xf bank_mask:0x2
  v_add_f32_dpp v59, v51, v47 row_ror:12 row_mask:0xf bank_mask:0x2
  v_add_f32_dpp v56, v54, v50 row_ror:12 row_mask:0xf bank_mask:0x4
  v_add_f32_dpp v58, v52, v48 row_ror:12 row_mask:0xf bank_mask:0x4
  v_add_f32_dpp v57, v43, v55 row_ror:12 row_mask:0xf bank_mask:0x8
  v_add_f32_dpp v59, v41, v53 row_ror:12 row_mask:0xf bank_mask:0x8
  v_add_f32_dpp v56, v58, v56 row_ror:8 row_mask:0xf bank_mask:0x5
  s_nop 1
  v_add_f32_dpp v56, v59, v57 row_ror:8 row_mask:0xf bank_mask:0xa
  v_cvt_pk_bf16_f32 v56, 0, v56
  v_mul_f32 v59, v56, v56
  v_mov_b32 v57, v56
  v_fma_f32 v59, v59, s57, v238
  v_mov_b32 v58, v56
  v_mul_f32 v59, v59, v56
  v_exp_f32 v59, v59
  v_permlane16_swap_b32 v57, v58
  v_add_f32 v59, 1.0, v59
  v_rcp_f32 v59, v59
  s_nop 0
  v_mul_f32 v56, v56, v59
  v_cvt_pk_bf16_f32 v56, 0, v56
  v_mul_f32 v56, v56, v58
  s_nop 1
  v_mov_b32_dpp v59, v56 row_shl:4 row_mask:0xf bank_mask:0xf
  v_cvt_pk_bf16_f32 v56, v56, v59
  v_min_u32 v56, -2, v56
  buffer_store_dword v56, v240, s[24:27], 0 offen sc1
  s_branch L_fin
L_f_row:
  s_lshl_b32 s42, s12, 2
  s_add_u32 s56, s42, s3
  s_mul_i32 s43, s56, 1280
  s_add_u32 s28, s64, s43
  s_addc_u32 s29, s65, 0
  s_mov_b32 s30, 1280
  s_mov_b32 s31, 0x00020000
  v_lshlrev_b32 v242, 2, v1
  buffer_load_dwordx2 v[32:33], v247, s[28:31], 0 offen
  buffer_load_dwordx2 v[34:35], v247, s[28:31], 0 offen offset:512
  buffer_load_dword v36, v242, s[28:31], 0 offen offset:1024
  s_mul_i32 s40, s56, 2560
  s_add_u32 s40, s40, 65536
  s_add_u32 s47, s40, 20480
  s_add_u32 s13, s40, 40960
  s_add_u32 s14, s40, 61440
  v_bfe_u32 v224, v0, 1, 2
  v_xor_b32 v225, s3, v224
  v_lshlrev_b32 v225, 4, v225
  v_lshl_add_u32 v225, v224, 8, v225
  v_bfe_u32 v224, v0, 3, 2
  v_lshl_add_u32 v225, v224, 6, v225
  v_bfe_u32 v224, v0, 5, 1
  v_lshl_add_u32 v225, v224, 10, v225
  v_and_b32 v224, 1, v0
  v_lshl_add_u32 v38, v224, 3, v225
  v_bfe_u32 v224, v0, 2, 2
  v_xor_b32 v225, s3, v224
  v_lshlrev_b32 v225, 4, v225
  v_lshl_add_u32 v225, v224, 8, v225
  v_lshl_add_u32 v225, v244, 6, v225
  v_and_b32 v224, 3, v0
  v_lshl_add_u32 v39, v224, 2, v225
  s_lshl_b32 s43, s3, 3
  v_mov_b32 v237, s43
  v_mov_b32 v236, 0x3f803f80
  s_mov_b32 s41, 0
  s_waitcnt vmcnt(0)
  v_mov_b32 v252, 0
  v_mov_b32 v253, 1
  s_mov_b64 exec, 1
  ds_add_u32 v252, v253 offset:6248
  s_mov_b64 exec, -1
  v_lshlrev_b32 v20, 16, v32
  v_and_b32 v21, 0xffff0000, v32
  v_lshlrev_b32 v22, 16, v33
  v_and_b32 v23, 0xffff0000, v33
  v_lshlrev_b32 v24, 16, v34
  v_and_b32 v25, 0xffff0000, v34
  v_lshlrev_b32 v26, 16, v35
  v_and_b32 v27, 0xffff0000, v35
  v_lshlrev_b32 v28, 16, v36
  v_and_b32 v29, 0xffff0000, v36
  s_mov_b64 exec, 1
L_fg:
  buffer_load_dword v160, v250, s[24:27], s40 offen sc1
  buffer_load_dword v172, v250, s[24:27], s47 offen sc1
  buffer_load_dword v184, v250, s[24:27], s13 offen sc1
  buffer_load_dword v196, v250, s[24:27], s14 offen sc1
  s_add_u32 s41, s41, 1
  s_cmp_gt_u32 s41, 400000
  s_cbranch_scc1 L_fg_ok
  s_waitcnt vmcnt(0)
L_fg_c:
  v_min3_u32 v253, v160, v172, v184
  v_min_u32 v253, v253, v196
  v_cmp_ne_u32 vcc, -1, v253
  s_cbranch_vccz L_fg
L_fg_ok:
  s_mov_b64 exec, -1
  buffer_load_dwordx4 v[160:163], v250, s[24:27], s40 offen sc1
  buffer_load_dwordx4 v[164:167], v250, s[24:27], s40 offen offset:1024 sc1
  buffer_load_dwordx2 v[168:169], v247, s[24:27], s40 offen offset:2048 sc1
  buffer_load_dwordx4 v[172:175], v250, s[24:27], s47 offen sc1
  buffer_load_dwordx4 v[176:179], v250, s[24:27], s47 offen offset:1024 sc1
  buffer_load_dwordx2 v[180:181], v247, s[24:27], s47 offen offset:2048 sc1
  buffer_load_dwordx4 v[184:187], v250, s[24:27], s13 offen sc1
  buffer_load_dwordx4 v[188:191], v250, s[24:27], s13 offen offset:1024 sc1
  buffer_load_dwordx2 v[192:193], v247, s[24:27], s13 offen offset:2048 sc1
  buffer_load_dwordx4 v[196:199], v250, s[24:27], s14 offen sc1
  buffer_load_dwordx4 v[200:203], v250, s[24:27], s14 offen offset:1024 sc1
  buffer_load_dwordx2 v[204:205], v247, s[24:27], s14 offen offset:2048 sc1
  s_waitcnt lgkmcnt(0)
L_hb_pg:
  s_waitcnt vmcnt(9)
  v_max_u32 v56, v160, v161
  v_max3_u32 v56, v56, v162, v163
  v_max3_u32 v56, v56, v164, v165
  v_max3_u32 v56, v56, v166, v167
  v_max3_u32 v56, v56, v168, v169
  s_waitcnt vmcnt(6)
  v_max_u32 v57, v172, v173
  v_max3_u32 v57, v57, v174, v175
  v_max3_u32 v57, v57, v176, v177
  v_max3_u32 v57, v57, v178, v179
  v_max3_u32 v57, v57, v180, v181
  v_pk_add_f32 v[8:9], v[160:161], v[172:173]
  v_pk_add_f32 v[10:11], v[162:163], v[174:175]
  v_pk_add_f32 v[12:13], v[164:165], v[176:177]
  v_pk_add_f32 v[14:15], v[166:167], v[178:179]
  v_pk_add_f32 v[16:17], v[168:169], v[180:181]
  s_waitcnt vmcnt(3)
  v_max_u32 v58, v184, v185
  v_max3_u32 v58, v58, v186, v187
  v_max3_u32 v58, v58, v188, v189
  v_max3_u32 v58, v58, v190, v191
  v_max3_u32 v58, v58, v192, v193
  v_max3_u32 v253, v56, v57, v58
  v_pk_add_f32 v[8:9], v[8:9], v[184:185]
  v_pk_add_f32 v[10:11], v[10:11], v[186:187]
  v_pk_add_f32 v[12:13], v[12:13], v[188:189]
  v_pk_add_f32 v[14:15], v[14:15], v[190:191]
  v_pk_add_f32 v[16:17], v[16:17], v[192:193]
  s_waitcnt vmcnt(0)
  v_max_u32 v59, v196, v197
  v_max3_u32 v59, v59, v198, v199
  v_max3_u32 v59, v59, v200, v201
  v_max3_u32 v59, v59, v202, v203
  v_max3_u32 v59, v59, v204, v205
  v_max_u32 v253, v253, v59
  v_cmp_eq_u32 vcc, -1, v253
  v_pk_add_f32 v[8:9], v[8:9], v[196:197]
  v_pk_add_f32 v[10:11], v[10:11], v[198:199]
  v_pk_add_f32 v[12:13], v[12:13], v[200:201]
  v_pk_add_f32 v[14:15], v[14:15], v[202:203]
  v_pk_add_f32 v[16:17], v[16:17], v[204:205]
  s_cbranch_vccnz L_hb_rt
L_hb_pd:
  v_cvt_pk_bf16_f32 v8, 0, v8
  v_cvt_pk_bf16_f32 v9, 0, v9
  v_cvt_pk_bf16_f32 v10, 0, v10
  v_cvt_pk_bf16_f32 v11, 0, v11
  v_cvt_pk_bf16_f32 v12, 0, v12
  v_cvt_pk_bf16_f32 v13, 0, v13
  v_cvt_pk_bf16_f32 v14, 0, v14
  v_cvt_pk_bf16_f32 v15, 0, v15
  v_cvt_pk_bf16_f32 v16, 0, v16
  v_cvt_pk_bf16_f32 v17, 0, v17
  v_pk_add_f32 v[8:9], v[8:9], v[20:21]
  v_pk_add_f32 v[10:11], v[10:11], v[22:23]
  v_pk_add_f32 v[12:13], v[12:13], v[24:25]
  v_pk_add_f32 v[14:15], v[14:15], v[26:27]
  v_pk_add_f32 v[16:17], v[16:17], v[28:29]
  v_cvt_pk_bf16_f32 v40, v8, v9
  v_cvt_pk_bf16_f32 v41, v10, v11
  v_cvt_pk_bf16_f32 v42, v12, v13
  v_cvt_pk_bf16_f32 v43, v14, v15
  v_cvt_pk_bf16_f32 v44, v16, v17
  v_dot2_f32_bf16 v234, v40, v236, 0
  v_dot2_f32_bf16 v235, v40, v40, 0
  v_dot2_f32_bf16 v234, v41, v236, v234
  v_dot2_f32_bf16 v235, v41, v41, v235
  v_dot2_f32_bf16 v234, v42, v236, v234
  v_dot2_f32_bf16 v235, v42, v42, v235
  v_dot2_f32_bf16 v234, v43, v236, v234
  v_dot2_f32_bf16 v235, v43, v43, v235
  v_dot2_f32_bf16 v234, v44, v236, v234
  v_dot2_f32_bf16 v235, v44, v44, v235
  v_lshlrev_b32 v224, 16, v40
  v_and_b32 v225, 0xffff0000, v40
  v_lshlrev_b32 v226, 16, v41
  v_add_f32_dpp v234, v234, v234 row_ror:8 row_mask:0xf bank_mask:0xf
  v_add_f32_dpp v235, v235, v235 row_ror:8 row_mask:0xf bank_mask:0xf
  v_and_b32 v227, 0xffff0000, v41
  v_add_f32_dpp v234, v234, v234 row_ror:4 row_mask:0xf bank_mask:0xf
  v_add_f32_dpp v235, v235, v235 row_ror:4 row_mask:0xf bank_mask:0xf
  v_lshlrev_b32 v228, 16, v42
  v_add_f32_dpp v234, v234, v234 row_ror:2 row_mask:0xf bank_mask:0xf
  v_add_f32_dpp v235, v235, v235 row_ror:2 row_mask:0xf bank_mask:0xf
  v_and_b32 v229, 0xffff0000, v42
  v_add_f32_dpp v234, v234, v234 row_ror:1 row_mask:0xf bank_mask:0xf
  v_add_f32_dpp v235, v235, v235 row_ror:1 row_mask:0xf bank_mask:0xf
  v_lshlrev_b32 v230, 16, v43
  v_add_f32_dpp v234, v234, v234 row_bcast:15 row_mask:0xa bank_mask:0xf
  v_add_f32_dpp v235, v235, v235 row_bcast:15 row_mask:0xa bank_mask:0xf
  v_and_b32 v231, 0xffff0000, v43
  v_add_f32_dpp v234, v234, v234 row_bcast:31 row_mask:0xc bank_mask:0xf
  v_add_f32_dpp v235, v235, v235 row_bcast:31 row_mask:0xc bank_mask:0xf
  v_lshlrev_b32 v232, 16, v44
  v_mul_f32 v234, 0x3acccccd, v234
  v_mul_f32 v235, 0x3acccccd, v235
  v_fma_f32 v235, -v234, v234, v235
  v_cvt_pk_bf16_f32 v234, 0, v234
  v_max_f32 v235, 0, v235
  v_readlane_b32 s42, v234, 63
  v_cvt_pk_bf16_f32 v235, 0, v235
  v_and_b32 v233, 0xffff0000, v44
  v_add_f32 v235, 0x3727c5ac, v235
  v_cvt_pk_bf16_f32 v235, 0, v235
  v_sqrt_f32 v235, v235
  v_pk_add_f32 v[224:225], v[224:225], s[42:43] op_sel_hi:[1,0] neg_lo:[0,1] neg_hi:[0,1]
  v_pk_add_f32 v[226:227], v[226:227], s[42:43] op_sel_hi:[1,0] neg_lo:[0,1] neg_hi:[0,1]
  v_cvt_pk_bf16_f32 v235, 0, v235
  v_rcp_f32 v235, v235
  v_pk_add_f32 v[228:229], v[228:229], s[42:43] op_sel_hi:[1,0] neg_lo:[0,1] neg_hi:[0,1]
  v_pk_add_f32 v[230:231], v[230:231], s[42:43] op_sel_hi:[1,0] neg_lo:[0,1] neg_hi:[0,1]
  v_pk_add_f32 v[232:233], v[232:233], s[42:43] op_sel_hi:[1,0] neg_lo:[0,1] neg_hi:[0,1]
  v_readlane_b32 s46, v235, 63
  v_cvt_pk_bf16_f32 v224, 0, v224
  v_cvt_pk_bf16_f32 v225, 0, v225
  v_cvt_pk_bf16_f32 v226, 0, v226
  v_cvt_pk_bf16_f32 v227, 0, v227
  v_cvt_pk_bf16_f32 v228, 0, v228
  v_cvt_pk_bf16_f32 v229, 0, v229
  v_cvt_pk_bf16_f32 v230, 0, v230
  v_cvt_pk_bf16_f32 v231, 0, v231
  v_cvt_pk_bf16_f32 v232, 0, v232
  v_cvt_pk_bf16_f32 v233, 0, v233
  v_pk_mul_f32 v[224:225], v[224:225], s[46:47] op_sel_hi:[1,0]
  v_pk_mul_f32 v[226:227], v[226:227], s[46:47] op_sel_hi:[1,0]
  v_pk_mul_f32 v[228:229], v[228:229], s[46:47] op_sel_hi:[1,0]
  v_pk_mul_f32 v[230:231], v[230:231], s[46:47] op_sel_hi:[1,0]
  v_pk_mul_f32 v[232:233], v[232:233], s[46:47] op_sel_hi:[1,0]
  v_cvt_pk_bf16_f32 v8, v224, v225
  v_cvt_pk_bf16_f32 v9, v226, v227
  v_cvt_pk_bf16_f32 v10, v228, v229
  v_cvt_pk_bf16_f32 v11, v230, v231
  v_cvt_pk_bf16_f32 v12, v232, v233
  ds_write_b64 v38, v[8:9] offset:8192
  ds_write_b64 v38, v[10:11] offset:10240
  ds_write_b32 v39, v12 offset:12288
  s_waitcnt lgkmcnt(0)
  s_barrier
  s_branch L_fin
L_down:
  s_mul_i32 s42, s3, 3584
  s_add_u32 s42, s42, 163840
  s_sub_u32 s43, 191488, s42
  s_mov_b32 s40, s42
  s_add_u32 s16, s86, s40
  s_addc_u32 s17, s87, 0
  s_mov_b32 s18, s43
  s_mov_b32 s19, 0x00020000
  v_and_b32 v224, 3, v0
  v_lshlrev_b32 v224, 4, v224
  v_lshl_add_u32 v224, v244, 6, v224
  v_bfe_u32 v227, v0, 2, 2
  v_lshl_add_u32 v224, v227, 8, v224
  v_and_b32 v227, 0x37, v1
  v_lshlrev_b32 v227, 4, v227
  v_bfe_u32 v228, v0, 3, 1
  v_lshl_add_u32 v227, v228, 3, v227
  v_lshlrev_b32 v229, 1, v244
  v_add_u32 v229, v229, v228
  s_movk_i32 s42, 1280
  v_mul_lo_u32 v230, v245, s42
  v_lshl_add_u32 v230, v229, 2, v230
  s_lshl_b32 s40, s45, 5
  s_add_u32 s28, s64, 0
  s_addc_u32 s29, s65, 0
  s_mov_b32 s30, 10240
  s_mov_b32 s31, 0x00020000
  buffer_load_dword v236, v230, s[28:31], s40 offen
  v_lshlrev_b32 v231, 1, v230
  s_lshl_b32 s47, s45, 6
  s_add_u32 s47, s47, 65536
  s_movk_i32 s42, 1280
  s_add_u32 s46, s47, 20480
  s_add_u32 s13, s47, 40960
  s_add_u32 s14, s47, 61440
  v_mul_lo_u32 v238, v245, s42
  v_lshrrev_b32 v239, 1, v244
  v_lshl_add_u32 v238, v239, 4, v238
  v_and_b32 v20, 0x18, v0
  v_cmp_eq_u32 vcc, 0, v20
  v_mov_b32 v20, 2147483632
  s_nop 0
  v_cndmask_b32 v238, v20, v238, vcc
  s_cmp_lg_u32 s3, 0
  s_cbranch_scc1 L_dn1
  s_mov_b32 s41, 0
  buffer_load_dwordx2 v[192:193], v231, s[24:27], s47 offen sc1
  buffer_load_dwordx2 v[194:195], v231, s[24:27], s46 offen sc1
  buffer_load_dwordx2 v[196:197], v231, s[24:27], s13 offen sc1
  buffer_load_dwordx2 v[198:199], v231, s[24:27], s14 offen sc1
  s_branch L_hd_chk
L_hd_rt:
  v_cmp_eq_u32 vcc, -1, v56
  s_nop 0
  s_mov_b64 exec, vcc
  buffer_load_dwordx2 v[192:193], v231, s[24:27], s47 offen sc1
  s_mov_b64 exec, -1
  v_cmp_eq_u32 vcc, -1, v57
  s_nop 0
  s_mov_b64 exec, vcc
  buffer_load_dwordx2 v[194:195], v231, s[24:27], s46 offen sc1
  s_mov_b64 exec, -1
  v_cmp_eq_u32 vcc, -1, v58
  s_nop 0
  s_mov_b64 exec, vcc
  buffer_load_dwordx2 v[196:197], v231, s[24:27], s13 offen sc1
  s_mov_b64 exec, -1
  v_cmp_eq_u32 vcc, -1, v59
  s_nop 0
  s_mov_b64 exec, vcc
  buffer_load_dwordx2 v[198:199], v231, s[24:27], s14 offen sc1
  s_mov_b64 exec, -1
  s_add_u32 s41, s41, 1
  s_cmp_gt_u32 s41, 400000
  s_cbranch_scc1 L_hd_ok
L_hd_chk:
  s_waitcnt vmcnt(0)
  v_max_u32 v56, v192, v193
  v_max_u32 v57, v194, v195
  v_max_u32 v58, v196, v197
  v_max_u32 v59, v198, v199
  v_max_u32 v253, v56, v57
  v_max3_u32 v253, v253, v58, v59
  v_cmp_eq_u32 vcc, -1, v253
  s_cbranch_vccnz L_hd_rt
L_hd_ok:
  v_lshlrev_b32 v232, 16, v236
  v_and_b32 v233, 0xffff0000, v236
  v_pk_add_f32 v[234:235], v[192:193], v[194:195]
  v_pk_add_f32 v[234:235], v[234:235], v[196:197]
  v_pk_add_f32 v[234:235], v[234:235], v[198:199]
  v_cvt_pk_bf16_f32 v234, 0, v234
  v_cvt_pk_bf16_f32 v235, 0, v235
  v_pk_add_f32 v[234:235], v[234:235], v[232:233]
  v_cvt_pk_bf16_f32 v240, 0, v234
  v_cvt_pk_bf16_f32 v241, 0, v235
  ds_write_b64 v247, v[240:241] offset:4096
L_dn1:
  s_mov_b32 s41, 0
  s_waitcnt vmcnt(0)
  ds_read_b64_tr_b16 v[80:81], v124 offset:0
  ds_read_b64_tr_b16 v[82:83], v124 offset:128
  ds_read_b64_tr_b16 v[84:85], v124 offset:1024
  ds_read_b64_tr_b16 v[86:87], v124 offset:1152
  ds_read_b64_tr_b16 v[88:89], v124 offset:2048
  ds_read_b64_tr_b16 v[90:91], v124 offset:2176
  ds_read_b64_tr_b16 v[92:93], v124 offset:3072
  ds_read_b64_tr_b16 v[94:95], v124 offset:3200
  ds_read_b64_tr_b16 v[96:97], v124 offset:4096
  ds_read_b64_tr_b16 v[98:99], v124 offset:4224
  ds_read_b64_tr_b16 v[100:101], v124 offset:5120
  ds_read_b64_tr_b16 v[102:103], v124 offset:5248
  ds_read_b64_tr_b16 v[104:105], v124 offset:6144
  ds_read_b64_tr_b16 v[106:107], v124 offset:6272
  s_cmp_lg_u32 s3, 0
  s_cbranch_scc1 L_d_gb
  v_mul_u32_u24 v232, 3328, v1
  s_mul_i32 s42, s45, 43
  s_lshr_b32 s42, s42, 8
  s_mul_i32 s42, s42, 6
  s_sub_u32 s42, s45, s42
  s_min_u32 s42, s42, 12
  s_lshl_b32 s47, s42, 8
  s_add_u32 s47, s47, 163840
  s_bfm_b64 exec, 8, 0
  buffer_load_dword v64, v232, s[24:27], s47 offen sc1
  s_mov_b32 s41, 0
L_d_g:
  s_waitcnt vmcnt(0)
  v_cmp_ne_u32 vcc, -1, v64
  s_nop 0
  s_bcnt1_i32_b64 s42, vcc
  s_cmp_ge_u32 s42, 1
  s_cbranch_scc1 L_d_gx
  buffer_load_dword v64, v232, s[24:27], s47 offen sc1
  s_add_u32 s41, s41, 1
  s_cmp_le_u32 s41, 200000
  s_cbranch_scc1 L_d_g
L_d_gx:
  s_mov_b64 exec, -1
L_d_gb:
  s_waitcnt lgkmcnt(0)
  s_barrier
  ds_read_b64 v[240:241], v247 offset:4096
  buffer_load_dwordx4 v[160:163], v224, s[16:19], 0 offen offset:0 sc1
  buffer_load_dwordx4 v[164:167], v224, s[16:19], 0 offen offset:1024 sc1
  buffer_load_dwordx4 v[168:171], v224, s[16:19], 0 offen offset:2048 sc1
  buffer_load_dwordx4 v[172:175], v224, s[16:19], 0 offen offset:3072 sc1
  s_waitcnt lgkmcnt(0)
L_ac_pg:
  s_waitcnt vmcnt(3)
  v_mfma_f32_16x16x32_bf16 v[72:75], v[80:83], v[160:163], 0
  v_max_u32 v56, v160, v161
  v_max3_u32 v56, v56, v162, v163
  v_mfma_f32_16x16x32_bf16 v[8:11], v[84:87], v[160:163], 0
  s_waitcnt vmcnt(2)
  v_mfma_f32_16x16x32_bf16 v[72:75], v[88:91], v[164:167], v[72:75]
  v_max_u32 v57, v164, v165
  v_max3_u32 v57, v57, v166, v167
  v_mfma_f32_16x16x32_bf16 v[8:11], v[92:95], v[164:167], v[8:11]
  s_waitcnt vmcnt(1)
  v_mfma_f32_16x16x32_bf16 v[72:75], v[96:99], v[168:171], v[72:75]
  v_max_u32 v58, v168, v169
  v_max3_u32 v58, v58, v170, v171
  v_max3_u32 v253, v56, v57, v58
  v_mfma_f32_16x16x32_bf16 v[8:11], v[100:103], v[168:171], v[8:11]
  s_waitcnt vmcnt(0)
  v_mfma_f32_16x16x32_bf16 v[72:75], v[104:107], v[172:175], v[72:75]
  v_max_u32 v59, v172, v173
  v_max3_u32 v59, v59, v174, v175
  v_max_u32 v253, v253, v59
  v_cmp_eq_u32 vcc, -1, v253
  s_cbranch_vccnz L_ac_rt
L_ac_pd:
  s_nop 2
  v_add_f32_dpp v72, v8, v72 row_ror:8 row_mask:0xf bank_mask:0xf
  v_add_f32_dpp v73, v9, v73 row_ror:8 row_mask:0xf bank_mask:0xf
  v_add_f32_dpp v74, v10, v74 row_ror:8 row_mask:0xf bank_mask:0xf
  v_add_f32_dpp v75, v11, v75 row_ror:8 row_mask:0xf bank_mask:0xf
  s_mov_b64 exec, s[62:63]
  ds_write_b128 v243, v[72:75] offset:16384
  s_mov_b64 exec, 1
  ds_add_rtn_u32 v242, v70, v71 offset:6248
  s_mov_b64 exec, -1
  ds_read_b64 v[80:81], v227 offset:16384
  ds_read_b64 v[82:83], v227 offset:18432
  ds_read_b64 v[84:85], v227 offset:20480
  ds_read_b64 v[86:87], v227 offset:22528
  ds_read_b64 v[88:89], v227 offset:24576
  ds_read_b64 v[90:91], v227 offset:26624
  ds_read_b64 v[92:93], v227 offset:28672
  ds_read_b64 v[94:95], v227 offset:30720
  s_waitcnt lgkmcnt(8)
  v_readfirstlane_b32 s42, v242
  s_nop 0
  s_cmp_lg_u32 s42, 7
  s_cbranch_scc1 L_fin
  s_waitcnt lgkmcnt(6)
  v_pk_add_f32 v[80:81], v[80:81], v[82:83]
  s_waitcnt lgkmcnt(5)
  v_pk_add_f32 v[80:81], v[80:81], v[84:85]
  s_waitcnt lgkmcnt(4)
  v_pk_add_f32 v[80:81], v[80:81], v[86:87]
  s_waitcnt lgkmcnt(3)
  v_pk_add_f32 v[80:81], v[80:81], v[88:89]
  s_waitcnt lgkmcnt(2)
  v_pk_add_f32 v[80:81], v[80:81], v[90:91]
  s_waitcnt lgkmcnt(1)
  v_pk_add_f32 v[80:81], v[80:81], v[92:93]
  s_waitcnt lgkmcnt(0)
  v_pk_add_f32 v[80:81], v[80:81], v[94:95]
  v_cvt_pk_bf16_f32 v82, 0, v80
  v_cvt_pk_bf16_f32 v83, 0, v81
  v_pk_add_f32 v[82:83], v[82:83], v[240:241]
  v_cvt_pk_bf16_f32 v8, v82, v83
  buffer_store_dword v8, v230, s[32:35], s40 offen
L_fin:
L_end:
  s_endpgm
L_wo_to:
  v_mfma_f32_16x16x32_bf16 v[72:75], v[80:83], v[160:163], 0
  v_mfma_f32_16x16x32_bf16 v[8:11], v[88:91], v[160:163], 0
  v_mfma_f32_16x16x32_bf16 v[76:79], v[84:87], v[160:163], 0
  s_branch L_wo_ok
L_hb_rt:
  v_cmp_eq_u32 vcc, -1, v56
  s_nop 0
  s_mov_b64 exec, vcc
  buffer_load_dwordx4 v[160:163], v250, s[24:27], s40 offen sc1
  buffer_load_dwordx4 v[164:167], v250, s[24:27], s40 offen offset:1024 sc1
  buffer_load_dwordx2 v[168:169], v247, s[24:27], s40 offen offset:2048 sc1
  s_mov_b64 exec, -1
  v_cmp_eq_u32 vcc, -1, v57
  s_nop 0
  s_mov_b64 exec, vcc
  buffer_load_dwordx4 v[172:175], v250, s[24:27], s47 offen sc1
  buffer_load_dwordx4 v[176:179], v250, s[24:27], s47 offen offset:1024 sc1
  buffer_load_dwordx2 v[180:181], v247, s[24:27], s47 offen offset:2048 sc1
  s_mov_b64 exec, -1
  v_cmp_eq_u32 vcc, -1, v58
  s_nop 0
  s_mov_b64 exec, vcc
  buffer_load_dwordx4 v[184:187], v250, s[24:27], s13 offen sc1
  buffer_load_dwordx4 v[188:191], v250, s[24:27], s13 offen offset:1024 sc1
  buffer_load_dwordx2 v[192:193], v247, s[24:27], s13 offen offset:2048 sc1
  s_mov_b64 exec, -1
  v_cmp_eq_u32 vcc, -1, v59
  s_nop 0
  s_mov_b64 exec, vcc
  buffer_load_dwordx4 v[196:199], v250, s[24:27], s14 offen sc1
  buffer_load_dwordx4 v[200:203], v250, s[24:27], s14 offen offset:1024 sc1
  buffer_load_dwordx2 v[204:205], v247, s[24:27], s14 offen offset:2048 sc1
  s_mov_b64 exec, -1
  s_add_u32 s41, s41, 1
  s_cmp_le_u32 s41, 400000
  s_cbranch_scc1 L_hb_pg
  s_waitcnt vmcnt(0)
  s_branch L_hb_pd
L_ac_rt:
  v_cmp_eq_u32 vcc, -1, v56
  s_nop 0
  s_mov_b64 exec, vcc
  buffer_load_dwordx4 v[160:163], v224, s[16:19], 0 offen offset:0 sc1
  s_mov_b64 exec, -1
  v_cmp_eq_u32 vcc, -1, v57
  s_nop 0
  s_mov_b64 exec, vcc
  buffer_load_dwordx4 v[164:167], v224, s[16:19], 0 offen offset:1024 sc1
  s_mov_b64 exec, -1
  v_cmp_eq_u32 vcc, -1, v58
  s_nop 0
  s_mov_b64 exec, vcc
  buffer_load_dwordx4 v[168:171], v224, s[16:19], 0 offen offset:2048 sc1
  s_mov_b64 exec, -1
  v_cmp_eq_u32 vcc, -1, v59
  s_nop 0
  s_mov_b64 exec, vcc
  buffer_load_dwordx4 v[172:175], v224, s[16:19], 0 offen offset:3072 sc1
  s_mov_b64 exec, -1
  s_add_u32 s41, s41, 1
  s_cmp_le_u32 s41, 400000
  s_waitcnt vmcnt(0)
  s_cbranch_scc1 L_ac_pg
  s_branch L_ac_pd
L_qto:
  v_mov_b32 v224, 1
  ds_write_b32 v33, v224 offset:6240
  s_branch L_qj0
L_qfb:
  s_waitcnt vmcnt(0)
  s_or_b32 s101, s101, 2
  v_bfe_u32 v9, v0, 4, 2
  s_mul_i32 s42, s3, 80
  v_add_u32 v10, s42, v9
  v_lshlrev_b32 v11, 4, v3
  v_lshl_add_u32 v12, v10, 13, v11
  v_add_u32 v14, 16, v3
  v_mov_b32 v13, v3
  v_subrev_u32 v16, 20, v13
  v_min_u32 v13, v13, v16
  v_lshl_add_u32 v13, v13, 2, v10
  v_lshlrev_b32 v13, 1, v13
  v_subrev_u32 v16, 20, v14
  v_min_u32 v14, v14, v16
  v_lshl_add_u32 v14, v14, 2, v10
  v_lshlrev_b32 v14, 1, v14
  s_mov_b32 s92, 0
  s_mul_i32 s47, s38, 1280
  s_add_u32 s28, s64, s47
  s_addc_u32 s29, s65, 0
  s_mov_b32 s30, 1280
  s_mov_b32 s31, 0x00020000
  buffer_load_dwordx4 v[240:243], v250, s[28:31], 0 offen
  buffer_load_dword v244, v15, s[28:31], 0 offen offset:1024
  buffer_load_ushort v245, v13, s[28:31], 0 offen
  buffer_load_ushort v239, v14, s[28:31], 0 offen
  s_sub_u32 s47, 5242880, s48
  s_add_u32 s16, s70, s48
  s_addc_u32 s17, s71, 0
  s_mov_b32 s18, s47
  s_mov_b32 s19, 0x00020000
  buffer_load_dwordx4 v[80:83], v12, s[16:19], s92 offen nt
  s_add_u32 s92, s92, 32768
  s_cmp_lg_u32 s92, 655360
  s_cselect_b32 s92, s92, 0
  buffer_load_dwordx4 v[84:87], v12, s[16:19], s92 offen nt
  s_add_u32 s92, s92, 32768
  s_cmp_lg_u32 s92, 655360
  s_cselect_b32 s92, s92, 0
  buffer_load_dwordx4 v[88:91], v12, s[16:19], s92 offen nt
  s_add_u32 s92, s92, 32768
  s_cmp_lg_u32 s92, 655360
  s_cselect_b32 s92, s92, 0
  buffer_load_dwordx4 v[92:95], v12, s[16:19], s92 offen nt
  s_add_u32 s92, s92, 32768
  s_cmp_lg_u32 s92, 655360
  s_cselect_b32 s92, s92, 0
  buffer_load_dwordx4 v[96:99], v12, s[16:19], s92 offen nt
  s_add_u32 s92, s92, 32768
  s_cmp_lg_u32 s92, 655360
  s_cselect_b32 s92, s92, 0
  buffer_load_dwordx4 v[100:103], v12, s[16:19], s92 offen nt
  s_add_u32 s92, s92, 32768
  s_cmp_lg_u32 s92, 655360
  s_cselect_b32 s92, s92, 0
  buffer_load_dwordx4 v[104:107], v12, s[16:19], s92 offen nt
  s_add_u32 s92, s92, 32768
  s_cmp_lg_u32 s92, 655360
  s_cselect_b32 s92, s92, 0
  buffer_load_dwordx4 v[108:111], v12, s[16:19], s92 offen nt
  s_add_u32 s92, s92, 32768
  s_cmp_lg_u32 s92, 655360
  s_cselect_b32 s92, s92, 0
  buffer_load_dwordx4 v[112:115], v12, s[16:19], s92 offen nt
  s_add_u32 s92, s92, 32768
  s_cmp_lg_u32 s92, 655360
  s_cselect_b32 s92, s92, 0
  buffer_load_dwordx4 v[116:119], v12, s[16:19], s92 offen nt
  s_add_u32 s92, s92, 32768
  s_cmp_lg_u32 s92, 655360
  s_cselect_b32 s92, s92, 0
  buffer_load_dwordx4 v[120:123], v12, s[16:19], s92 offen nt
  s_add_u32 s92, s92, 32768
  s_cmp_lg_u32 s92, 655360
  s_cselect_b32 s92, s92, 0
  buffer_load_dwordx4 v[124:127], v12, s[16:19], s92 offen nt
  s_add_u32 s92, s92, 32768
  s_cmp_lg_u32 s92, 655360
  s_cselect_b32 s92, s92, 0
  buffer_load_dwordx4 v[128:131], v12, s[16:19], s92 offen nt
  s_add_u32 s92, s92, 32768
  s_cmp_lg_u32 s92, 655360
  s_cselect_b32 s92, s92, 0
  buffer_load_dwordx4 v[132:135], v12, s[16:19], s92 offen nt
  s_add_u32 s92, s92, 32768
  s_cmp_lg_u32 s92, 655360
  s_cselect_b32 s92, s92, 0
  buffer_load_dwordx4 v[136:139], v12, s[16:19], s92 offen nt
  s_add_u32 s92, s92, 32768
  s_cmp_lg_u32 s92, 655360
  s_cselect_b32 s92, s92, 0
  buffer_load_dwordx4 v[140:143], v12, s[16:19], s92 offen nt
  s_add_u32 s92, s92, 32768
  s_cmp_lg_u32 s92, 655360
  s_cselect_b32 s92, s92, 0
  buffer_load_dwordx4 v[144:147], v12, s[16:19], s92 offen nt
  s_add_u32 s92, s92, 32768
  s_cmp_lg_u32 s92, 655360
  s_cselect_b32 s92, s92, 0
  buffer_load_dwordx4 v[148:151], v12, s[16:19], s92 offen nt
  s_add_u32 s92, s92, 32768
  s_cmp_lg_u32 s92, 655360
  s_cselect_b32 s92, s92, 0
  buffer_load_dwordx4 v[152:155], v12, s[16:19], s92 offen nt
  s_add_u32 s92, s92, 32768
  s_cmp_lg_u32 s92, 655360
  s_cselect_b32 s92, s92, 0
  buffer_load_dwordx4 v[156:159], v12, s[16:19], s92 offen nt
  s_waitcnt vmcnt(20)
  v_lshlrev_b32 v224, 16, v240
  v_and_b32 v225, 0xffff0000, v240
  v_lshlrev_b32 v226, 16, v241
  v_and_b32 v227, 0xffff0000, v241
  v_lshlrev_b32 v228, 16, v242
  v_and_b32 v229, 0xffff0000, v242
  v_lshlrev_b32 v230, 16, v243
  v_and_b32 v231, 0xffff0000, v243
  v_lshlrev_b32 v232, 16, v244
  v_and_b32 v233, 0xffff0000, v244
  v_readfirstlane_b32 s42, v224
  s_nop 1
  v_subrev_f32 v234, s42, v224
  v_mul_f32 v235, v234, v234
  v_subrev_f32 v236, s42, v225
  v_add_f32 v234, v234, v236
  v_fmac_f32 v235, v236, v236
  v_subrev_f32 v236, s42, v226
  v_add_f32 v234, v234, v236
  v_fmac_f32 v235, v236, v236
  v_subrev_f32 v236, s42, v227
  v_add_f32 v234, v234, v236
  v_fmac_f32 v235, v236, v236
  v_subrev_f32 v236, s42, v228
  v_add_f32 v234, v234, v236
  v_fmac_f32 v235, v236, v236
  v_subrev_f32 v236, s42, v229
  v_add_f32 v234, v234, v236
  v_fmac_f32 v235, v236, v236
  v_subrev_f32 v236, s42, v230
  v_add_f32 v234, v234, v236
  v_fmac_f32 v235, v236, v236
  v_subrev_f32 v236, s42, v231
  v_add_f32 v234, v234, v236
  v_fmac_f32 v235, v236, v236
  v_subrev_f32 v236, s42, v232
  v_add_f32 v234, v234, v236
  v_fmac_f32 v235, v236, v236
  v_subrev_f32 v236, s42, v233
  v_add_f32 v234, v234, v236
  v_fmac_f32 v235, v236, v236
  s_nop 0
  v_add_f32_dpp v234, v234, v234 row_ror:8 row_mask:0xf bank_mask:0xf
  v_add_f32_dpp v235, v235, v235 row_ror:8 row_mask:0xf bank_mask:0xf
  s_nop 0
  v_add_f32_dpp v234, v234, v234 row_ror:4 row_mask:0xf bank_mask:0xf
  v_add_f32_dpp v235, v235, v235 row_ror:4 row_mask:0xf bank_mask:0xf
  s_nop 0
  v_add_f32_dpp v234, v234, v234 row_ror:2 row_mask:0xf bank_mask:0xf
  v_add_f32_dpp v235, v235, v235 row_ror:2 row_mask:0xf bank_mask:0xf
  s_nop 0
  v_add_f32_dpp v234, v234, v234 row_ror:1 row_mask:0xf bank_mask:0xf
  v_add_f32_dpp v235, v235, v235 row_ror:1 row_mask:0xf bank_mask:0xf
  v_mov_b32 v252, v234
  v_mov_b32 v253, v235
  s_nop 0
  v_permlane16_swap_b32 v234, v252
  v_permlane16_swap_b32 v235, v253
  v_add_f32 v234, v234, v252
  v_add_f32 v235, v235, v253
  v_mov_b32 v252, v234
  v_mov_b32 v253, v235
  s_nop 0
  v_permlane32_swap_b32 v234, v252
  v_permlane32_swap_b32 v235, v253
  v_add_f32 v234, v234, v252
  v_add_f32 v235, v235, v253
  s_mov_b32 s43, 0x3acccccd
  v_mul_f32 v234, s43, v234
  v_mul_f32 v235, s43, v235
  v_fma_f32 v235, -v234, v234, v235
  v_max_f32 v235, 0, v235
  v_add_f32 v234, s42, v234
  v_cvt_pk_bf16_f32 v237, 0, v234
  v_cvt_pk_bf16_f32 v235, 0, v235
  v_add_f32 v235, 0x3727c5ac, v235
  v_cvt_pk_bf16_f32 v235, 0, v235
  v_sqrt_f32 v235, v235
  s_nop 0
  v_cvt_pk_bf16_f32 v235, 0, v235
  v_rcp_f32 v238, v235
  v_lshlrev_b32 v245, 16, v245
  v_sub_f32 v245, v245, v237
  v_cvt_pk_bf16_f32 v245, 0, v245
  v_mul_f32 v245, v245, v238
  v_cvt_pk_bf16_f32 v240, v245, 0
  v_lshlrev_b32 v241, 16, v240
  v_lshlrev_b32 v239, 16, v239
  v_sub_f32 v239, v239, v237
  v_cvt_pk_bf16_f32 v239, 0, v239
  v_mul_f32 v239, v239, v238
  v_cvt_pk_bf16_f32 v242, v239, 0
  v_lshlrev_b32 v243, 16, v242
  s_waitcnt vmcnt(19)
  v_dot2c_f32_bf16_dpp v72, v240, v80 row_newbcast:0 row_mask:0xf bank_mask:0xf
  v_dot2c_f32_bf16_dpp v73, v241, v80 row_newbcast:0 row_mask:0xf bank_mask:0xf
  v_dot2c_f32_bf16_dpp v74, v240, v81 row_newbcast:0 row_mask:0xf bank_mask:0xf
  v_dot2c_f32_bf16_dpp v75, v241, v81 row_newbcast:0 row_mask:0xf bank_mask:0xf
  v_dot2c_f32_bf16_dpp v76, v240, v82 row_newbcast:0 row_mask:0xf bank_mask:0xf
  v_dot2c_f32_bf16_dpp v77, v241, v82 row_newbcast:0 row_mask:0xf bank_mask:0xf
  v_dot2c_f32_bf16_dpp v78, v240, v83 row_newbcast:0 row_mask:0xf bank_mask:0xf
  v_dot2c_f32_bf16_dpp v79, v241, v83 row_newbcast:0 row_mask:0xf bank_mask:0xf
  s_waitcnt vmcnt(18)
  v_dot2c_f32_bf16_dpp v72, v240, v84 row_newbcast:1 row_mask:0xf bank_mask:0xf
  v_dot2c_f32_bf16_dpp v73, v241, v84 row_newbcast:1 row_mask:0xf bank_mask:0xf
  v_dot2c_f32_bf16_dpp v74, v240, v85 row_newbcast:1 row_mask:0xf bank_mask:0xf
  v_dot2c_f32_bf16_dpp v75, v241, v85 row_newbcast:1 row_mask:0xf bank_mask:0xf
  v_dot2c_f32_bf16_dpp v76, v240, v86 row_newbcast:1 row_mask:0xf bank_mask:0xf
  v_dot2c_f32_bf16_dpp v77, v241, v86 row_newbcast:1 row_mask:0xf bank_mask:0xf
  v_dot2c_f32_bf16_dpp v78, v240, v87 row_newbcast:1 row_mask:0xf bank_mask:0xf
  v_dot2c_f32_bf16_dpp v79, v241, v87 row_newbcast:1 row_mask:0xf bank_mask:0xf
  s_waitcnt vmcnt(17)
  v_dot2c_f32_bf16_dpp v72, v240, v88 row_newbcast:2 row_mask:0xf bank_mask:0xf
  v_dot2c_f32_bf16_dpp v73, v241, v88 row_newbcast:2 row_mask:0xf bank_mask:0xf
  v_dot2c_f32_bf16_dpp v74, v240, v89 row_newbcast:2 row_mask:0xf bank_mask:0xf
  v_dot2c_f32_bf16_dpp v75, v241, v89 row_newbcast:2 row_mask:0xf bank_mask:0xf
  v_dot2c_f32_bf16_dpp v76, v240, v90 row_newbcast:2 row_mask:0xf bank_mask:0xf
  v_dot2c_f32_bf16_dpp v77, v241, v90 row_newbcast:2 row_mask:0xf bank_mask:0xf
  v_dot2c_f32_bf16_dpp v78, v240, v91 row_newbcast:2 row_mask:0xf bank_mask:0xf
  v_dot2c_f32_bf16_dpp v79, v241, v91 row_newbcast:2 row_mask:0xf bank_mask:0xf
  s_waitcnt vmcnt(16)
  v_dot2c_f32_bf16_dpp v72, v240, v92 row_newbcast:3 row_mask:0xf bank_mask:0xf
  v_dot2c_f32_bf16_dpp v73, v241, v92 row_newbcast:3 row_mask:0xf bank_mask:0xf
  v_dot2c_f32_bf16_dpp v74, v240, v93 row_newbcast:3 row_mask:0xf bank_mask:0xf
  v_dot2c_f32_bf16_dpp v75, v241, v93 row_newbcast:3 row_mask:0xf bank_mask:0xf
  v_dot2c_f32_bf16_dpp v76, v240, v94 row_newbcast:3 row_mask:0xf bank_mask:0xf
  v_dot2c_f32_bf16_dpp v77, v241, v94 row_newbcast:3 row_mask:0xf bank_mask:0xf
  v_dot2c_f32_bf16_dpp v78, v240, v95 row_newbcast:3 row_mask:0xf bank_mask:0xf
  v_dot2c_f32_bf16_dpp v79, v241, v95 row_newbcast:3 row_mask:0xf bank_mask:0xf
  s_waitcnt vmcnt(15)
  v_dot2c_f32_bf16_dpp v72, v240, v96 row_newbcast:4 row_mask:0xf bank_mask:0xf
  v_dot2c_f32_bf16_dpp v73, v241, v96 row_newbcast:4 row_mask:0xf bank_mask:0xf
  v_dot2c_f32_bf16_dpp v74, v240, v97 row_newbcast:4 row_mask:0xf bank_mask:0xf
  v_dot2c_f32_bf16_dpp v75, v241, v97 row_newbcast:4 row_mask:0xf bank_mask:0xf
  v_dot2c_f32_bf16_dpp v76, v240, v98 row_newbcast:4 row_mask:0xf bank_mask:0xf
  v_dot2c_f32_bf16_dpp v77, v241, v98 row_newbcast:4 row_mask:0xf bank_mask:0xf
  v_dot2c_f32_bf16_dpp v78, v240, v99 row_newbcast:4 row_mask:0xf bank_mask:0xf
  v_dot2c_f32_bf16_dpp v79, v241, v99 row_newbcast:4 row_mask:0xf bank_mask:0xf
  s_waitcnt vmcnt(14)
  v_dot2c_f32_bf16_dpp v72, v240, v100 row_newbcast:5 row_mask:0xf bank_mask:0xf
  v_dot2c_f32_bf16_dpp v73, v241, v100 row_newbcast:5 row_mask:0xf bank_mask:0xf
  v_dot2c_f32_bf16_dpp v74, v240, v101 row_newbcast:5 row_mask:0xf bank_mask:0xf
  v_dot2c_f32_bf16_dpp v75, v241, v101 row_newbcast:5 row_mask:0xf bank_mask:0xf
  v_dot2c_f32_bf16_dpp v76, v240, v102 row_newbcast:5 row_mask:0xf bank_mask:0xf
  v_dot2c_f32_bf16_dpp v77, v241, v102 row_newbcast:5 row_mask:0xf bank_mask:0xf
  v_dot2c_f32_bf16_dpp v78, v240, v103 row_newbcast:5 row_mask:0xf bank_mask:0xf
  v_dot2c_f32_bf16_dpp v79, v241, v103 row_newbcast:5 row_mask:0xf bank_mask:0xf
  s_waitcnt vmcnt(13)
  v_dot2c_f32_bf16_dpp v72, v240, v104 row_newbcast:6 row_mask:0xf bank_mask:0xf
  v_dot2c_f32_bf16_dpp v73, v241, v104 row_newbcast:6 row_mask:0xf bank_mask:0xf
  v_dot2c_f32_bf16_dpp v74, v240, v105 row_newbcast:6 row_mask:0xf bank_mask:0xf
  v_dot2c_f32_bf16_dpp v75, v241, v105 row_newbcast:6 row_mask:0xf bank_mask:0xf
  v_dot2c_f32_bf16_dpp v76, v240, v106 row_newbcast:6 row_mask:0xf bank_mask:0xf
  v_dot2c_f32_bf16_dpp v77, v241, v106 row_newbcast:6 row_mask:0xf bank_mask:0xf
  v_dot2c_f32_bf16_dpp v78, v240, v107 row_newbcast:6 row_mask:0xf bank_mask:0xf
  v_dot2c_f32_bf16_dpp v79, v241, v107 row_newbcast:6 row_mask:0xf bank_mask:0xf
  s_waitcnt vmcnt(12)
  v_dot2c_f32_bf16_dpp v72, v240, v108 row_newbcast:7 row_mask:0xf bank_mask:0xf
  v_dot2c_f32_bf16_dpp v73, v241, v108 row_newbcast:7 row_mask:0xf bank_mask:0xf
  v_dot2c_f32_bf16_dpp v74, v240, v109 row_newbcast:7 row_mask:0xf bank_mask:0xf
  v_dot2c_f32_bf16_dpp v75, v241, v109 row_newbcast:7 row_mask:0xf bank_mask:0xf
  v_dot2c_f32_bf16_dpp v76, v240, v110 row_newbcast:7 row_mask:0xf bank_mask:0xf
  v_dot2c_f32_bf16_dpp v77, v241, v110 row_newbcast:7 row_mask:0xf bank_mask:0xf
  v_dot2c_f32_bf16_dpp v78, v240, v111 row_newbcast:7 row_mask:0xf bank_mask:0xf
  v_dot2c_f32_bf16_dpp v79, v241, v111 row_newbcast:7 row_mask:0xf bank_mask:0xf
  s_waitcnt vmcnt(11)
  v_dot2c_f32_bf16_dpp v72, v240, v112 row_newbcast:8 row_mask:0xf bank_mask:0xf
  v_dot2c_f32_bf16_dpp v73, v241, v112 row_newbcast:8 row_mask:0xf bank_mask:0xf
  v_dot2c_f32_bf16_dpp v74, v240, v113 row_newbcast:8 row_mask:0xf bank_mask:0xf
  v_dot2c_f32_bf16_dpp v75, v241, v113 row_newbcast:8 row_mask:0xf bank_mask:0xf
  v_dot2c_f32_bf16_dpp v76, v240, v114 row_newbcast:8 row_mask:0xf bank_mask:0xf
  v_dot2c_f32_bf16_dpp v77, v241, v114 row_newbcast:8 row_mask:0xf bank_mask:0xf
  v_dot2c_f32_bf16_dpp v78, v240, v115 row_newbcast:8 row_mask:0xf bank_mask:0xf
  v_dot2c_f32_bf16_dpp v79, v241, v115 row_newbcast:8 row_mask:0xf bank_mask:0xf
  s_waitcnt vmcnt(10)
  v_dot2c_f32_bf16_dpp v72, v240, v116 row_newbcast:9 row_mask:0xf bank_mask:0xf
  v_dot2c_f32_bf16_dpp v73, v241, v116 row_newbcast:9 row_mask:0xf bank_mask:0xf
  v_dot2c_f32_bf16_dpp v74, v240, v117 row_newbcast:9 row_mask:0xf bank_mask:0xf
  v_dot2c_f32_bf16_dpp v75, v241, v117 row_newbcast:9 row_mask:0xf bank_mask:0xf
  v_dot2c_f32_bf16_dpp v76, v240, v118 row_newbcast:9 row_mask:0xf bank_mask:0xf
  v_dot2c_f32_bf16_dpp v77, v241, v118 row_newbcast:9 row_mask:0xf bank_mask:0xf
  v_dot2c_f32_bf16_dpp v78, v240, v119 row_newbcast:9 row_mask:0xf bank_mask:0xf
  v_dot2c_f32_bf16_dpp v79, v241, v119 row_newbcast:9 row_mask:0xf bank_mask:0xf
  s_waitcnt vmcnt(9)
  v_dot2c_f32_bf16_dpp v72, v240, v120 row_newbcast:10 row_mask:0xf bank_mask:0xf
  v_dot2c_f32_bf16_dpp v73, v241, v120 row_newbcast:10 row_mask:0xf bank_mask:0xf
  v_dot2c_f32_bf16_dpp v74, v240, v121 row_newbcast:10 row_mask:0xf bank_mask:0xf
  v_dot2c_f32_bf16_dpp v75, v241, v121 row_newbcast:10 row_mask:0xf bank_mask:0xf
  v_dot2c_f32_bf16_dpp v76, v240, v122 row_newbcast:10 row_mask:0xf bank_mask:0xf
  v_dot2c_f32_bf16_dpp v77, v241, v122 row_newbcast:10 row_mask:0xf bank_mask:0xf
  v_dot2c_f32_bf16_dpp v78, v240, v123 row_newbcast:10 row_mask:0xf bank_mask:0xf
  v_dot2c_f32_bf16_dpp v79, v241, v123 row_newbcast:10 row_mask:0xf bank_mask:0xf
  s_waitcnt vmcnt(8)
  v_dot2c_f32_bf16_dpp v72, v240, v124 row_newbcast:11 row_mask:0xf bank_mask:0xf
  v_dot2c_f32_bf16_dpp v73, v241, v124 row_newbcast:11 row_mask:0xf bank_mask:0xf
  v_dot2c_f32_bf16_dpp v74, v240, v125 row_newbcast:11 row_mask:0xf bank_mask:0xf
  v_dot2c_f32_bf16_dpp v75, v241, v125 row_newbcast:11 row_mask:0xf bank_mask:0xf
  v_dot2c_f32_bf16_dpp v76, v240, v126 row_newbcast:11 row_mask:0xf bank_mask:0xf
  v_dot2c_f32_bf16_dpp v77, v241, v126 row_newbcast:11 row_mask:0xf bank_mask:0xf
  v_dot2c_f32_bf16_dpp v78, v240, v127 row_newbcast:11 row_mask:0xf bank_mask:0xf
  v_dot2c_f32_bf16_dpp v79, v241, v127 row_newbcast:11 row_mask:0xf bank_mask:0xf
  s_waitcnt vmcnt(7)
  v_dot2c_f32_bf16_dpp v72, v240, v128 row_newbcast:12 row_mask:0xf bank_mask:0xf
  v_dot2c_f32_bf16_dpp v73, v241, v128 row_newbcast:12 row_mask:0xf bank_mask:0xf
  v_dot2c_f32_bf16_dpp v74, v240, v129 row_newbcast:12 row_mask:0xf bank_mask:0xf
  v_dot2c_f32_bf16_dpp v75, v241, v129 row_newbcast:12 row_mask:0xf bank_mask:0xf
  v_dot2c_f32_bf16_dpp v76, v240, v130 row_newbcast:12 row_mask:0xf bank_mask:0xf
  v_dot2c_f32_bf16_dpp v77, v241, v130 row_newbcast:12 row_mask:0xf bank_mask:0xf
  v_dot2c_f32_bf16_dpp v78, v240, v131 row_newbcast:12 row_mask:0xf bank_mask:0xf
  v_dot2c_f32_bf16_dpp v79, v241, v131 row_newbcast:12 row_mask:0xf bank_mask:0xf
  s_waitcnt vmcnt(6)
  v_dot2c_f32_bf16_dpp v72, v240, v132 row_newbcast:13 row_mask:0xf bank_mask:0xf
  v_dot2c_f32_bf16_dpp v73, v241, v132 row_newbcast:13 row_mask:0xf bank_mask:0xf
  v_dot2c_f32_bf16_dpp v74, v240, v133 row_newbcast:13 row_mask:0xf bank_mask:0xf
  v_dot2c_f32_bf16_dpp v75, v241, v133 row_newbcast:13 row_mask:0xf bank_mask:0xf
  v_dot2c_f32_bf16_dpp v76, v240, v134 row_newbcast:13 row_mask:0xf bank_mask:0xf
  v_dot2c_f32_bf16_dpp v77, v241, v134 row_newbcast:13 row_mask:0xf bank_mask:0xf
  v_dot2c_f32_bf16_dpp v78, v240, v135 row_newbcast:13 row_mask:0xf bank_mask:0xf
  v_dot2c_f32_bf16_dpp v79, v241, v135 row_newbcast:13 row_mask:0xf bank_mask:0xf
  s_waitcnt vmcnt(5)
  v_dot2c_f32_bf16_dpp v72, v240, v136 row_newbcast:14 row_mask:0xf bank_mask:0xf
  v_dot2c_f32_bf16_dpp v73, v241, v136 row_newbcast:14 row_mask:0xf bank_mask:0xf
  v_dot2c_f32_bf16_dpp v74, v240, v137 row_newbcast:14 row_mask:0xf bank_mask:0xf
  v_dot2c_f32_bf16_dpp v75, v241, v137 row_newbcast:14 row_mask:0xf bank_mask:0xf
  v_dot2c_f32_bf16_dpp v76, v240, v138 row_newbcast:14 row_mask:0xf bank_mask:0xf
  v_dot2c_f32_bf16_dpp v77, v241, v138 row_newbcast:14 row_mask:0xf bank_mask:0xf
  v_dot2c_f32_bf16_dpp v78, v240, v139 row_newbcast:14 row_mask:0xf bank_mask:0xf
  v_dot2c_f32_bf16_dpp v79, v241, v139 row_newbcast:14 row_mask:0xf bank_mask:0xf
  s_waitcnt vmcnt(4)
  v_dot2c_f32_bf16_dpp v72, v240, v140 row_newbcast:15 row_mask:0xf bank_mask:0xf
  v_dot2c_f32_bf16_dpp v73, v241, v140 row_newbcast:15 row_mask:0xf bank_mask:0xf
  v_dot2c_f32_bf16_dpp v74, v240, v141 row_newbcast:15 row_mask:0xf bank_mask:0xf
  v_dot2c_f32_bf16_dpp v75, v241, v141 row_newbcast:15 row_mask:0xf bank_mask:0xf
  v_dot2c_f32_bf16_dpp v76, v240, v142 row_newbcast:15 row_mask:0xf bank_mask:0xf
  v_dot2c_f32_bf16_dpp v77, v241, v142 row_newbcast:15 row_mask:0xf bank_mask:0xf
  v_dot2c_f32_bf16_dpp v78, v240, v143 row_newbcast:15 row_mask:0xf bank_mask:0xf
  v_dot2c_f32_bf16_dpp v79, v241, v143 row_newbcast:15 row_mask:0xf bank_mask:0xf
  s_waitcnt vmcnt(3)
  v_dot2c_f32_bf16_dpp v72, v242, v144 row_newbcast:0 row_mask:0xf bank_mask:0xf
  v_dot2c_f32_bf16_dpp v73, v243, v144 row_newbcast:0 row_mask:0xf bank_mask:0xf
  v_dot2c_f32_bf16_dpp v74, v242, v145 row_newbcast:0 row_mask:0xf bank_mask:0xf
  v_dot2c_f32_bf16_dpp v75, v243, v145 row_newbcast:0 row_mask:0xf bank_mask:0xf
  v_dot2c_f32_bf16_dpp v76, v242, v146 row_newbcast:0 row_mask:0xf bank_mask:0xf
  v_dot2c_f32_bf16_dpp v77, v243, v146 row_newbcast:0 row_mask:0xf bank_mask:0xf
  v_dot2c_f32_bf16_dpp v78, v242, v147 row_newbcast:0 row_mask:0xf bank_mask:0xf
  v_dot2c_f32_bf16_dpp v79, v243, v147 row_newbcast:0 row_mask:0xf bank_mask:0xf
  s_waitcnt vmcnt(2)
  v_dot2c_f32_bf16_dpp v72, v242, v148 row_newbcast:1 row_mask:0xf bank_mask:0xf
  v_dot2c_f32_bf16_dpp v73, v243, v148 row_newbcast:1 row_mask:0xf bank_mask:0xf
  v_dot2c_f32_bf16_dpp v74, v242, v149 row_newbcast:1 row_mask:0xf bank_mask:0xf
  v_dot2c_f32_bf16_dpp v75, v243, v149 row_newbcast:1 row_mask:0xf bank_mask:0xf
  v_dot2c_f32_bf16_dpp v76, v242, v150 row_newbcast:1 row_mask:0xf bank_mask:0xf
  v_dot2c_f32_bf16_dpp v77, v243, v150 row_newbcast:1 row_mask:0xf bank_mask:0xf
  v_dot2c_f32_bf16_dpp v78, v242, v151 row_newbcast:1 row_mask:0xf bank_mask:0xf
  v_dot2c_f32_bf16_dpp v79, v243, v151 row_newbcast:1 row_mask:0xf bank_mask:0xf
  s_waitcnt vmcnt(1)
  v_dot2c_f32_bf16_dpp v72, v242, v152 row_newbcast:2 row_mask:0xf bank_mask:0xf
  v_dot2c_f32_bf16_dpp v73, v243, v152 row_newbcast:2 row_mask:0xf bank_mask:0xf
  v_dot2c_f32_bf16_dpp v74, v242, v153 row_newbcast:2 row_mask:0xf bank_mask:0xf
  v_dot2c_f32_bf16_dpp v75, v243, v153 row_newbcast:2 row_mask:0xf bank_mask:0xf
  v_dot2c_f32_bf16_dpp v76, v242, v154 row_newbcast:2 row_mask:0xf bank_mask:0xf
  v_dot2c_f32_bf16_dpp v77, v243, v154 row_newbcast:2 row_mask:0xf bank_mask:0xf
  v_dot2c_f32_bf16_dpp v78, v242, v155 row_newbcast:2 row_mask:0xf bank_mask:0xf
  v_dot2c_f32_bf16_dpp v79, v243, v155 row_newbcast:2 row_mask:0xf bank_mask:0xf
  s_waitcnt vmcnt(0)
  v_dot2c_f32_bf16_dpp v72, v242, v156 row_newbcast:3 row_mask:0xf bank_mask:0xf
  v_dot2c_f32_bf16_dpp v73, v243, v156 row_newbcast:3 row_mask:0xf bank_mask:0xf
  v_dot2c_f32_bf16_dpp v74, v242, v157 row_newbcast:3 row_mask:0xf bank_mask:0xf
  v_dot2c_f32_bf16_dpp v75, v243, v157 row_newbcast:3 row_mask:0xf bank_mask:0xf
  v_dot2c_f32_bf16_dpp v76, v242, v158 row_newbcast:3 row_mask:0xf bank_mask:0xf
  v_dot2c_f32_bf16_dpp v77, v243, v158 row_newbcast:3 row_mask:0xf bank_mask:0xf
  v_dot2c_f32_bf16_dpp v78, v242, v159 row_newbcast:3 row_mask:0xf bank_mask:0xf
  v_dot2c_f32_bf16_dpp v79, v243, v159 row_newbcast:3 row_mask:0xf bank_mask:0xf
  v_permlane32_swap_b32 v72, v76
  v_permlane32_swap_b32 v73, v77
  v_permlane32_swap_b32 v74, v78
  v_permlane32_swap_b32 v75, v79
  v_add_f32 v72, v72, v76
  v_add_f32 v73, v73, v77
  v_add_f32 v74, v74, v78
  v_add_f32 v75, v75, v79
  s_nop 0
  v_permlane16_swap_b32 v72, v74
  v_permlane16_swap_b32 v73, v75
  v_add_f32 v72, v72, v74
  v_add_f32 v73, v73, v75
  ds_write_b64 v246, v[72:73] offset:0
  s_waitcnt lgkmcnt(0)
  s_barrier
  ds_read_b64 v[224:225], v247 offset:0
  ds_read_b64 v[226:227], v247 offset:512
  ds_read_b64 v[228:229], v247 offset:1024
  ds_read_b64 v[230:231], v247 offset:1536
  ds_read_b64 v[232:233], v247 offset:2048
  ds_read_b64 v[234:235], v247 offset:2560
  ds_read_b64 v[236:237], v247 offset:3072
  ds_read_b64 v[238:239], v247 offset:3584
  s_waitcnt lgkmcnt(6)
  v_pk_add_f32 v[224:225], v[224:225], v[226:227]
  s_waitcnt lgkmcnt(5)
  v_pk_add_f32 v[224:225], v[224:225], v[228:229]
  s_waitcnt lgkmcnt(4)
  v_pk_add_f32 v[224:225], v[224:225], v[230:231]
  s_waitcnt lgkmcnt(3)
  v_pk_add_f32 v[224:225], v[224:225], v[232:233]
  s_waitcnt lgkmcnt(2)
  v_pk_add_f32 v[224:225], v[224:225], v[234:235]
  s_waitcnt lgkmcnt(1)
  v_pk_add_f32 v[224:225], v[224:225], v[236:237]
  s_waitcnt lgkmcnt(0)
  v_pk_add_f32 v[224:225], v[224:225], v[238:239]
  v_cvt_pk_bf16_f32 v240, v224, v225
  s_lshl_b32 s42, s3, 8
  v_lshl_add_u32 v241, v1, 2, s42
  v_lshl_add_u32 v242, v3, 4, s42
  ds_write_b32 v241, v240 offset:4096
  s_waitcnt lgkmcnt(0)
  ds_read_b128 v[4:7], v242 offset:4096
  s_waitcnt lgkmcnt(0)
  s_cmp_eq_u32 s3, 0
  s_cbranch_scc1 L_qokP
  s_mov_b32 s42, 131072
  buffer_load_dwordx4 v[128:131], v2, s[4:7], s42 offen offset:0 nt
  s_mov_b32 s42, 139264
  buffer_load_dwordx4 v[132:135], v2, s[4:7], s42 offen offset:0 nt
  s_waitcnt vmcnt(0)
  s_branch L_qokU
L_rs0:
  s_cmp_lg_u32 s101, 0
  s_cbranch_scc1 L_rs0b
  s_branch L_o_done
L_rs1:
  s_cmp_lg_u32 s101, 0
  s_cbranch_scc1 L_o_dn2
  s_waitcnt vmcnt(0) lgkmcnt(0)
  s_mov_b32 s101, 1
  s_branch L_start
.section .rodata,"a"
.p2align 6
.amdhsa_kernel sequential_preLN__mha_block_cached__geglu_ffn__decode_kernel
  .amdhsa_next_free_vgpr 256
  .amdhsa_next_free_sgpr 102
  .amdhsa_accum_offset 256
  .amdhsa_group_segment_fixed_size 0
  .amdhsa_kernarg_size 96
  .amdhsa_user_sgpr_count 2
  .amdhsa_user_sgpr_kernarg_segment_ptr 1
  .amdhsa_system_sgpr_workgroup_id_x 1
.end_amdhsa_kernel
```
